```python
import torch

def _softmax(x, axis=-1):
    return torch.softmax(x, dim=axis)
def _gelu(x):
    return torch.nn.functional.gelu(x, approximate="tanh")
def _silu(x):
    return torch.nn.functional.silu(x)
def _sigmoid(x):
    return torch.sigmoid(x)
def _layernorm(x, axis=-1, eps=1e-5):
    m = x.mean(dim=axis, keepdim=True)
    v = x.var(dim=axis, keepdim=True, unbiased=False)
    return (x - m) / torch.sqrt(v + eps)
def _scatter_add(tgt, idx, src, axis=0):
    return tgt.clone().index_add_(axis, idx, src)
def _segment_sum(src, seg, n):
    out = torch.zeros((n,) + src.shape[1:], dtype=src.dtype)
    return out.index_add_(0, seg, src)
def _pad(x, pw):
    flat = tuple(v for pair in reversed(pw) for v in pair)
    return torch.nn.functional.pad(x, flat)

kernel_name = 'standalone__w4a16_gemm_dequant__prompt'

def setup_inputs():

    _w = (lambda a: (lambda t: t.to(torch.bfloat16) if t.is_floating_point() else t)(torch.as_tensor(a)))
    B, S, D, F = 1, 2048, 576, 4608
    G = 32 if 32 > 0 else D
    D = (D // G) * G
    ng = D // G
    qw = torch.randint(0, 16, (D, F)).to(torch.int32)
    return {
        "x": _w((lambda *s: torch.randn(*s, dtype=torch.bfloat16) * 0.05)(B, S, D)),
        "qw": _w(qw),
        "scales": _w(torch.abs((lambda *s: torch.randn(*s, dtype=torch.bfloat16) * 0.05)(ng, F)) + 0.01),
        "zeros": _w(torch.full((ng, F), 8.0, dtype=float)),
    }

def reference(x, qw, scales, zeros):
    B, S, D = x.shape
    ng, F = scales.shape
    G = D // ng
    s = (lambda x, n, axis: torch.repeat_interleave(x, n, dim=axis))(scales, G, axis=0)
    z = (lambda x, n, axis: torch.repeat_interleave(x, n, dim=axis))(zeros, G, axis=0)
    w = ((lambda x, dt: x.to(dt))(qw, x.dtype) - z) * s
    return x @ w
```

```asm
; @launch grid=(252,1,1) block=(512,1,1) lds=163840
.amdgcn_target "amdgcn-amd-amdhsa--gfx950"
.text
.globl standalone__w4a16_gemm_dequant__prompt_kernel
.p2align 12
.p2align 8
.type standalone__w4a16_gemm_dequant__prompt_kernel,@function
standalone__w4a16_gemm_dequant__prompt_kernel:
  s_cmp_ge_u32 s2, 252
  s_cbranch_scc1 L_end
  s_load_dwordx8 s[4:11], s[0:1], 0
  s_load_dwordx2 s[12:13], s[0:1], 32
  s_getpc_b64 s[40:41]
L_pc:
  s_and_b32 s41, s41, 0xffff
  s_mov_b32 s42, L_end-L_pc
  s_mov_b32 s43, 0x20000
  s_lshr_b32 s15, s2, 3
  s_lshl_b32 s15, s15, 7
  v_lshl_add_u32 v79, v0, 12, s15
  buffer_load_dword v95, v79, s[40:43], 0 offen
  s_nop 4
  v_lshrrev_b32 v64, 6, v0
  v_and_b32 v1, 63, v0
  v_readfirstlane_b32 s34, v64
  s_and_b32 s14, s2, 7
  s_lshr_b32 s15, s2, 3
  s_lshl_b32 s18, s14, 2
  s_and_b32 s19, s15, 3
  s_add_u32 s18, s18, s19
  s_lshr_b32 s19, s15, 2
  s_and_b32 s40, s14, 3
  s_add_u32 s40, s40, 32
  s_and_b32 s41, s14, 4
  s_add_u32 s41, s41, s15
  s_sub_u32 s41, s41, 28
  s_cmp_ge_u32 s15, 28
  s_cselect_b32 s18, s40, s18
  s_cselect_b32 s15, s41, s19
  s_and_b32 s3, s34, 3
  s_lshr_b32 s100, s3, 1
  s_and_b32 s35, s3, 1
  s_lshl_b32 s42, s18, 7
  s_lshl_b32 s40, s35, 6
  s_add_u32 s42, s42, s40
  v_and_b32 v64, 15, v1
  v_lshrrev_b32 v65, 4, v1
  s_bitcmp1_b32 s34, 2
  s_cbranch_scc1 L_cons
  s_lshl_b32 s40, s15, 2
  s_lshr_b32 s40, 57028656, s40
  s_and_b32 s40, s40, 15
  s_add_u32 s40, s40, s14
  s_sub_u32 s41, s40, 9
  s_min_u32 s19, s40, s41
  s_mov_b32 s18, s42
  s_mul_i32 s42, s19, 1179648
  s_mul_i32 s43, s100, 589824
  s_lshl2_add_u32 s43, s18, s43
  s_add_u32 s42, s42, s43
  v_mul_u32_u24 v2, 147456, v65
  v_lshl_add_u32 v2, v64, 4, v2
  v_add_u32 v2, s42, v2
  s_mov_b32 s26, 10616832
  s_mov_b32 s27, 0x20000
  s_mov_b32 s41, 18432
  s_mov_b32 s42, 36864
  s_mov_b32 s43, 55296
  s_mov_b32 s44, 73728
  s_mov_b32 s45, 92160
  s_mov_b32 s46, 110592
  s_mov_b32 s47, 129024
  s_mov_b32 s32, 1383358768
  s_cmp_eq_u32 s15, 1
  s_cmov_b32 s32, 2237952304
  s_cmp_eq_u32 s15, 2
  s_cmov_b32 s32, 1985229328
  s_cmp_eq_u32 s15, 3
  s_cmov_b32 s32, 1985229328
  s_cmp_eq_u32 s15, 4
  s_cmov_b32 s32, 1985229328
  s_cmp_eq_u32 s15, 5
  s_cmov_b32 s32, 1985229328
  s_cmp_eq_u32 s15, 6
  s_cmov_b32 s32, 1985229328
  s_lshl_b32 s40, s15, 2
  s_lshr_b32 s33, 143165480, s40
  s_and_b32 s33, s33, 15
  s_mul_i32 s40, s100, 9216
  s_lshl1_add_u32 s40, s18, s40
  v_lshl_add_u32 v66, v64, 3, s40
  v_lshlrev_b32 v75, 2, v65
  v_bfe_u32 v67, s32, v75, 4
  v_add_u32 v67, s19, v67
  v_add_u32 v68, -9, v67
  v_min_u32 v68, v67, v68
  v_mad_u32_u24 v9, v68, s41, v66
  s_mov_b32 s30, 165888
  s_mov_b32 s31, 0x20000
  s_waitcnt lgkmcnt(0)
  s_mov_b32 s24, s6
  s_and_b32 s25, s7, 0xffff
  buffer_load_dwordx4 v[96:99], v2, s[24:27], 0 offen
  buffer_load_dwordx4 v[100:103], v2, s[24:27], s41 offen
  buffer_load_dwordx4 v[104:107], v2, s[24:27], s42 offen
  buffer_load_dwordx4 v[108:111], v2, s[24:27], s43 offen
  buffer_load_dwordx4 v[112:115], v2, s[24:27], s44 offen
  buffer_load_dwordx4 v[116:119], v2, s[24:27], s45 offen
  buffer_load_dwordx4 v[120:123], v2, s[24:27], s46 offen
  buffer_load_dwordx4 v[124:127], v2, s[24:27], s47 offen
  s_mov_b32 s28, s8
  s_and_b32 s29, s9, 0xffff
  buffer_load_dwordx2 v[12:13], v9, s[28:31], 0 offen
  v_add_u32 v75, 16, v75
  v_bfe_u32 v67, s32, v75, 4
  v_add_u32 v67, s19, v67
  v_add_u32 v68, -9, v67
  v_min_u32 v68, v67, v68
  v_mad_u32_u24 v10, v68, s41, v66
  buffer_load_dwordx2 v[14:15], v10, s[28:31], 0 offen
  s_add_u32 s40, s19, s33
  v_mov_b32 v67, s40
  v_add_u32 v68, -9, v67
  v_min_u32 v68, v67, v68
  v_mad_u32_u24 v11, v68, s41, v66
  buffer_load_dwordx2 v[16:17], v11, s[28:31], 0 offen
  s_mul_i32 s14, s15, 18
  s_min_u32 s40, s15, 2
  s_add_u32 s14, s14, s40
  s_cmp_lt_u32 s15, 2
  s_cselect_b32 s101, 19, 18
  s_mul_i32 s15, s14, 18432
  s_add_u32 s20, s4, s15
  s_addc_u32 s21, s5, 0
  s_and_b32 s21, s21, 0xffff
  s_mul_i32 s22, s101, 18432
  s_mov_b32 s23, 0x20000
  v_lshrrev_b32 v69, 3, v1
  v_lshrrev_b32 v70, 4, v1
  v_and_b32 v70, 2, v70
  v_lshrrev_b32 v71, 2, v1
  v_and_b32 v71, 4, v71
  v_and_b32 v72, 7, v1
  v_xor_b32 v71, v71, v72
  v_xor_b32 v70, v70, v71
  v_mul_u32_u24 v69, 1152, v69
  v_lshl_add_u32 v70, v70, 4, v69
  s_mul_i32 s15, s100, 18432
  s_mul_i32 s40, s35, 9216
  s_add_u32 s40, s40, s15
  s_lshl_b32 s15, s19, 7
  s_add_u32 s40, s40, s15
  v_add_u32 v3, s40, v70
  s_lshl_b32 s40, s35, 10
  s_lshl_b32 s8, s100, 11
  s_add_u32 s8, s8, s40
  s_mov_b32 s48, 36864
  s_mov_b32 s49, 73728
  s_mov_b32 s50, 110592
  s_mov_b32 s51, 147456
  s_mov_b32 s52, 184320
  s_mov_b32 s53, 221184
  s_mov_b32 s54, 258048
  s_mov_b32 s55, 294912
  s_cmp_eq_u32 s101, 18
  s_cbranch_scc1 L_beg0b
L_beg0a:
  s_add_u32 m0, s8, 41984
  s_nop 0
  buffer_load_dwordx4 v3, s[20:23], 0 offen lds
  s_add_u32 m0, s8, 46080
  s_nop 0
  buffer_load_dwordx4 v3, s[20:23], s48 offen lds
  s_add_u32 m0, s8, 50176
  s_nop 0
  buffer_load_dwordx4 v3, s[20:23], s49 offen lds
  s_add_u32 m0, s8, 54272
  s_nop 0
  buffer_load_dwordx4 v3, s[20:23], s50 offen lds
  s_add_u32 m0, s8, 58368
  s_nop 0
  buffer_load_dwordx4 v3, s[20:23], s51 offen lds
  s_add_u32 m0, s8, 62464
  s_nop 0
  buffer_load_dwordx4 v3, s[20:23], s52 offen lds
  s_lshl_b32 s40, s35, 1
  v_xor_b32 v71, s40, v71
  v_lshl_add_u32 v71, v71, 4, v69
  s_mul_i32 s40, s3, 4608
  s_add_u32 s40, s40, s15
  s_add_u32 s40, s40, 331776
  v_add_u32 v76, s40, v71
  s_lshl_b32 s9, s3, 9
  s_mov_b32 s10, 0x4b800000
  s_mov_b32 s11, 0xffff0000
  s_mul_i32 s40, s3, 2304
  s_add_u32 s40, s40, 32768
  v_lshl_add_u32 v5, v64, 4, s40
  v_lshl_add_u32 v6, v65, 8, v5
  s_lshl_b32 s40, s3, 12
  v_lshl_add_u32 v7, v1, 4, s40
  v_mov_b32 v1, v76
  s_bfe_u32 s15, s32, 262148
  s_add_u32 s15, s15, s19
  s_sub_u32 s40, s15, 9
  s_min_u32 s15, s15, s40
  s_sub_u32 s64, s15, s19
  s_mul_i32 s56, s64, 9
  s_bfe_u32 s14, s32, 262152
  s_add_u32 s14, s14, s19
  s_sub_u32 s40, s14, 9
  s_min_u32 s14, s14, s40
  s_sub_u32 s65, s14, s15
  s_mul_i32 s57, s65, 9
  s_bfe_u32 s15, s32, 262156
  s_add_u32 s15, s15, s19
  s_sub_u32 s40, s15, 9
  s_min_u32 s15, s15, s40
  s_sub_u32 s66, s15, s14
  s_mul_i32 s58, s66, 9
  s_bfe_u32 s14, s32, 262160
  s_add_u32 s14, s14, s19
  s_sub_u32 s40, s14, 9
  s_min_u32 s14, s14, s40
  s_sub_u32 s67, s14, s15
  s_mul_i32 s59, s67, 9
  s_bfe_u32 s15, s32, 262164
  s_add_u32 s15, s15, s19
  s_sub_u32 s40, s15, 9
  s_min_u32 s15, s15, s40
  s_sub_u32 s68, s15, s14
  s_mul_i32 s60, s68, 9
  s_bfe_u32 s14, s32, 262168
  s_add_u32 s14, s14, s19
  s_sub_u32 s40, s14, 9
  s_min_u32 s14, s14, s40
  s_sub_u32 s69, s14, s15
  s_mul_i32 s61, s69, 9
  s_bfe_u32 s15, s32, 262172
  s_add_u32 s15, s15, s19
  s_sub_u32 s40, s15, 9
  s_min_u32 s15, s15, s40
  s_sub_u32 s70, s15, s14
  s_mul_i32 s62, s70, 9
  s_mov_b32 s14, s33
  s_add_u32 s14, s14, s19
  s_sub_u32 s40, s14, 9
  s_min_u32 s14, s14, s40
  s_sub_u32 s71, s14, s15
  s_mul_i32 s63, s71, 9
  s_add_u32 m0, s8, 66560
  s_nop 0
  buffer_load_dwordx4 v3, s[20:23], s53 offen lds
  s_add_u32 m0, s8, 70656
  s_nop 0
  buffer_load_dwordx4 v3, s[20:23], s54 offen lds
  s_add_u32 m0, s8, 74752
  s_nop 0
  buffer_load_dwordx4 v3, s[20:23], s55 offen lds
  s_waitcnt vmcnt(11)
  v_lshlrev_b32 v84, 16, v12
  v_and_b32 v85, s11, v12
  v_lshlrev_b32 v86, 16, v13
  v_and_b32 v87, s11, v13
  v_mul_f32 v84, s10, v84
  v_mul_f32 v85, s10, v85
  v_mul_f32 v86, s10, v86
  v_mul_f32 v87, s10, v87
  ds_write_b128 v6, v[84:87] offset:0
  ds_read_b128 v[20:23], v5 offset:0
  s_waitcnt vmcnt(10)
  v_lshlrev_b32 v88, 16, v14
  v_and_b32 v89, s11, v14
  v_lshlrev_b32 v90, 16, v15
  v_and_b32 v91, s11, v15
  v_mul_f32 v88, s10, v88
  v_mul_f32 v89, s10, v89
  v_mul_f32 v90, s10, v90
  v_mul_f32 v91, s10, v91
  ds_write_b128 v6, v[88:91] offset:1024
  s_waitcnt lgkmcnt(1)
  v_mul_f32 v28, 0xb5000000, v20
  v_mul_f32 v29, 0xb5000000, v21
  v_mul_f32 v30, 0xb5000000, v22
  v_mul_f32 v31, 0xb5000000, v23
  v_fma_mix_f32 v96, v96, v20, v28 op_sel_hi:[1,0,0]
  v_fma_mix_f32 v97, v97, v21, v29 op_sel_hi:[1,0,0]
  v_fma_mix_f32 v98, v98, v22, v30 op_sel_hi:[1,0,0]
  v_fma_mix_f32 v99, v99, v23, v31 op_sel_hi:[1,0,0]
  v_fma_mix_f32 v100, v100, v20, v28 op_sel_hi:[1,0,0]
  s_add_u32 m0, s9, 78848
  s_nop 0
  s_mov_b32 exec_hi, 0
  buffer_load_dwordx4 v1, s[20:23], 0 offen lds
  s_mov_b32 exec_hi, -1
  v_fma_mix_f32 v101, v101, v21, v29 op_sel_hi:[1,0,0]
  v_fma_mix_f32 v102, v102, v22, v30 op_sel_hi:[1,0,0]
  v_fma_mix_f32 v103, v103, v23, v31 op_sel_hi:[1,0,0]
  v_cvt_pk_bf16_f32 v32, v96, v100
  v_cvt_pk_bf16_f32 v36, v97, v101
  v_lshl_add_u32 v2, s56, 17, v2
  buffer_load_dwordx4 v[128:131], v2, s[24:27], 0 offen
  v_cvt_pk_bf16_f32 v40, v98, v102
  v_cvt_pk_bf16_f32 v44, v99, v103
  v_fma_mix_f32 v104, v104, v20, v28 op_sel_hi:[1,0,0]
  v_fma_mix_f32 v105, v105, v21, v29 op_sel_hi:[1,0,0]
  v_fma_mix_f32 v106, v106, v22, v30 op_sel_hi:[1,0,0]
  buffer_load_dwordx4 v[132:135], v2, s[24:27], s41 offen
  v_fma_mix_f32 v107, v107, v23, v31 op_sel_hi:[1,0,0]
  v_fma_mix_f32 v108, v108, v20, v28 op_sel_hi:[1,0,0]
  v_fma_mix_f32 v109, v109, v21, v29 op_sel_hi:[1,0,0]
  v_fma_mix_f32 v110, v110, v22, v30 op_sel_hi:[1,0,0]
  v_fma_mix_f32 v111, v111, v23, v31 op_sel_hi:[1,0,0]
  buffer_load_dwordx4 v[136:139], v2, s[24:27], s42 offen
  v_cvt_pk_bf16_f32 v33, v104, v108
  v_cvt_pk_bf16_f32 v37, v105, v109
  v_cvt_pk_bf16_f32 v41, v106, v110
  v_cvt_pk_bf16_f32 v45, v107, v111
  v_fma_mix_f32 v112, v112, v20, v28 op_sel_hi:[1,0,0]
  buffer_load_dwordx4 v[140:143], v2, s[24:27], s43 offen
  v_fma_mix_f32 v113, v113, v21, v29 op_sel_hi:[1,0,0]
  v_fma_mix_f32 v114, v114, v22, v30 op_sel_hi:[1,0,0]
  v_fma_mix_f32 v115, v115, v23, v31 op_sel_hi:[1,0,0]
  v_fma_mix_f32 v116, v116, v20, v28 op_sel_hi:[1,0,0]
  v_fma_mix_f32 v117, v117, v21, v29 op_sel_hi:[1,0,0]
  buffer_load_dwordx4 v[144:147], v2, s[24:27], s44 offen
  v_fma_mix_f32 v118, v118, v22, v30 op_sel_hi:[1,0,0]
  v_fma_mix_f32 v119, v119, v23, v31 op_sel_hi:[1,0,0]
  v_cvt_pk_bf16_f32 v34, v112, v116
  v_cvt_pk_bf16_f32 v38, v113, v117
  v_cvt_pk_bf16_f32 v42, v114, v118
  buffer_load_dwordx4 v[148:151], v2, s[24:27], s45 offen
  v_cvt_pk_bf16_f32 v46, v115, v119
  v_fma_mix_f32 v120, v120, v20, v28 op_sel_hi:[1,0,0]
  v_fma_mix_f32 v121, v121, v21, v29 op_sel_hi:[1,0,0]
  v_fma_mix_f32 v122, v122, v22, v30 op_sel_hi:[1,0,0]
  v_fma_mix_f32 v123, v123, v23, v31 op_sel_hi:[1,0,0]
  buffer_load_dwordx4 v[152:155], v2, s[24:27], s46 offen
  v_fma_mix_f32 v124, v124, v20, v28 op_sel_hi:[1,0,0]
  v_fma_mix_f32 v125, v125, v21, v29 op_sel_hi:[1,0,0]
  v_fma_mix_f32 v126, v126, v22, v30 op_sel_hi:[1,0,0]
  v_fma_mix_f32 v127, v127, v23, v31 op_sel_hi:[1,0,0]
  v_cvt_pk_bf16_f32 v35, v120, v124
  buffer_load_dwordx4 v[156:159], v2, s[24:27], s47 offen
  v_cvt_pk_bf16_f32 v39, v121, v125
  v_cvt_pk_bf16_f32 v43, v122, v126
  v_cvt_pk_bf16_f32 v47, v123, v127
  s_waitcnt vmcnt(18)
  v_lshlrev_b32 v92, 16, v16
  v_and_b32 v93, s11, v16
  v_lshlrev_b32 v94, 16, v17
  v_and_b32 v95, s11, v17
  v_mul_f32 v92, s10, v92
  v_mul_f32 v93, s10, v93
  v_mul_f32 v94, s10, v94
  v_mul_f32 v95, s10, v95
  s_mov_b64 exec, 0xffff
  ds_write_b128 v6, v[92:95] offset:2048
  s_mov_b64 exec, -1
  ds_read_b128 v[24:27], v5 offset:256
  ds_write_b128 v7, v[32:35] offset:0
  ds_write_b128 v7, v[36:39] offset:1024
  ds_write_b128 v7, v[40:43] offset:2048
  ds_write_b128 v7, v[44:47] offset:3072
  v_lshl_add_u32 v3, s64, 7, v3
  s_add_u32 m0, s8, 80896
  s_nop 0
  buffer_load_dwordx4 v3, s[20:23], 0 offen lds
  s_add_u32 m0, s8, 84992
  s_nop 0
  buffer_load_dwordx4 v3, s[20:23], s48 offen lds
  s_waitcnt lgkmcnt(4)
  v_mul_f32 v28, 0xb5000000, v24
  s_waitcnt vmcnt(10) lgkmcnt(0)
  s_barrier
  v_mul_f32 v29, 0xb5000000, v25
  v_mul_f32 v30, 0xb5000000, v26
  s_add_u32 m0, s8, 89088
  s_nop 0
  buffer_load_dwordx4 v3, s[20:23], s49 offen lds
  v_mul_f32 v31, 0xb5000000, v27
  s_waitcnt vmcnt(10)
  v_fma_mix_f32 v128, v128, v24, v28 op_sel_hi:[1,0,0]
  v_fma_mix_f32 v129, v129, v25, v29 op_sel_hi:[1,0,0]
  v_fma_mix_f32 v130, v130, v26, v30 op_sel_hi:[1,0,0]
  v_fma_mix_f32 v131, v131, v27, v31 op_sel_hi:[1,0,0]
  s_add_u32 m0, s8, 93184
  s_nop 0
  buffer_load_dwordx4 v3, s[20:23], s50 offen lds
  s_waitcnt vmcnt(10)
  v_fma_mix_f32 v132, v132, v24, v28 op_sel_hi:[1,0,0]
  v_fma_mix_f32 v133, v133, v25, v29 op_sel_hi:[1,0,0]
  v_fma_mix_f32 v134, v134, v26, v30 op_sel_hi:[1,0,0]
  v_fma_mix_f32 v135, v135, v27, v31 op_sel_hi:[1,0,0]
  v_cvt_pk_bf16_f32 v48, v128, v132
  s_add_u32 m0, s8, 97280
  s_nop 0
  buffer_load_dwordx4 v3, s[20:23], s51 offen lds
  v_cvt_pk_bf16_f32 v52, v129, v133
  v_cvt_pk_bf16_f32 v56, v130, v134
  v_cvt_pk_bf16_f32 v60, v131, v135
  s_waitcnt vmcnt(10)
  v_fma_mix_f32 v136, v136, v24, v28 op_sel_hi:[1,0,0]
  v_fma_mix_f32 v137, v137, v25, v29 op_sel_hi:[1,0,0]
  s_add_u32 m0, s8, 101376
  s_nop 0
  buffer_load_dwordx4 v3, s[20:23], s52 offen lds
  v_fma_mix_f32 v138, v138, v26, v30 op_sel_hi:[1,0,0]
  v_fma_mix_f32 v139, v139, v27, v31 op_sel_hi:[1,0,0]
  s_waitcnt vmcnt(10)
  v_fma_mix_f32 v140, v140, v24, v28 op_sel_hi:[1,0,0]
  v_fma_mix_f32 v141, v141, v25, v29 op_sel_hi:[1,0,0]
  v_fma_mix_f32 v142, v142, v26, v30 op_sel_hi:[1,0,0]
  s_add_u32 m0, s8, 105472
  s_nop 0
  buffer_load_dwordx4 v3, s[20:23], s53 offen lds
  v_fma_mix_f32 v143, v143, v27, v31 op_sel_hi:[1,0,0]
  v_cvt_pk_bf16_f32 v49, v136, v140
  v_cvt_pk_bf16_f32 v53, v137, v141
  v_cvt_pk_bf16_f32 v57, v138, v142
  v_cvt_pk_bf16_f32 v61, v139, v143
  s_add_u32 m0, s8, 109568
  s_nop 0
  buffer_load_dwordx4 v3, s[20:23], s54 offen lds
  s_waitcnt vmcnt(11)
  v_fma_mix_f32 v144, v144, v24, v28 op_sel_hi:[1,0,0]
  v_fma_mix_f32 v145, v145, v25, v29 op_sel_hi:[1,0,0]
  v_fma_mix_f32 v146, v146, v26, v30 op_sel_hi:[1,0,0]
  v_fma_mix_f32 v147, v147, v27, v31 op_sel_hi:[1,0,0]
  s_waitcnt vmcnt(10)
  v_fma_mix_f32 v148, v148, v24, v28 op_sel_hi:[1,0,0]
  s_add_u32 m0, s8, 113664
  s_nop 0
  buffer_load_dwordx4 v3, s[20:23], s55 offen lds
  v_fma_mix_f32 v149, v149, v25, v29 op_sel_hi:[1,0,0]
  v_fma_mix_f32 v150, v150, v26, v30 op_sel_hi:[1,0,0]
  v_fma_mix_f32 v151, v151, v27, v31 op_sel_hi:[1,0,0]
  v_cvt_pk_bf16_f32 v50, v144, v148
  v_cvt_pk_bf16_f32 v54, v145, v149
  v_lshl_add_u32 v1, s64, 7, v1
  s_add_u32 m0, s9, 117760
  s_nop 0
  s_mov_b32 exec_hi, 0
  buffer_load_dwordx4 v1, s[20:23], 0 offen lds
  s_mov_b32 exec_hi, -1
  v_cvt_pk_bf16_f32 v58, v146, v150
  v_cvt_pk_bf16_f32 v62, v147, v151
  s_waitcnt vmcnt(11)
  v_fma_mix_f32 v152, v152, v24, v28 op_sel_hi:[1,0,0]
  v_fma_mix_f32 v153, v153, v25, v29 op_sel_hi:[1,0,0]
  v_fma_mix_f32 v154, v154, v26, v30 op_sel_hi:[1,0,0]
  v_lshl_add_u32 v2, s57, 17, v2
  buffer_load_dwordx4 v[160:163], v2, s[24:27], 0 offen
  v_fma_mix_f32 v155, v155, v27, v31 op_sel_hi:[1,0,0]
  s_waitcnt vmcnt(11)
  v_fma_mix_f32 v156, v156, v24, v28 op_sel_hi:[1,0,0]
  v_fma_mix_f32 v157, v157, v25, v29 op_sel_hi:[1,0,0]
  v_fma_mix_f32 v158, v158, v26, v30 op_sel_hi:[1,0,0]
  v_fma_mix_f32 v159, v159, v27, v31 op_sel_hi:[1,0,0]
  buffer_load_dwordx4 v[164:167], v2, s[24:27], s41 offen
  v_cvt_pk_bf16_f32 v51, v152, v156
  v_cvt_pk_bf16_f32 v55, v153, v157
  v_cvt_pk_bf16_f32 v59, v154, v158
  v_cvt_pk_bf16_f32 v63, v155, v159
  ds_read_b128 v[20:23], v5 offset:512
  ds_write_b128 v7, v[48:51] offset:16384
  buffer_load_dwordx4 v[168:171], v2, s[24:27], s42 offen
  ds_write_b128 v7, v[52:55] offset:17408
  buffer_load_dwordx4 v[172:175], v2, s[24:27], s43 offen
  ds_write_b128 v7, v[56:59] offset:18432
  buffer_load_dwordx4 v[176:179], v2, s[24:27], s44 offen
  ds_write_b128 v7, v[60:63] offset:19456
  buffer_load_dwordx4 v[180:183], v2, s[24:27], s45 offen
  buffer_load_dwordx4 v[184:187], v2, s[24:27], s46 offen
  buffer_load_dwordx4 v[188:191], v2, s[24:27], s47 offen
  v_lshl_add_u32 v3, s65, 7, v3
  s_add_u32 m0, s8, 119808
  s_nop 0
  buffer_load_dwordx4 v3, s[20:23], 0 offen lds
  s_add_u32 m0, s8, 123904
  s_nop 0
  buffer_load_dwordx4 v3, s[20:23], s48 offen lds
  s_waitcnt lgkmcnt(4)
  v_mul_f32 v28, 0xb5000000, v20
  s_waitcnt vmcnt(10) lgkmcnt(0)
  s_barrier
  v_mul_f32 v29, 0xb5000000, v21
  v_mul_f32 v30, 0xb5000000, v22
  s_add_u32 m0, s8, 128000
  s_nop 0
  buffer_load_dwordx4 v3, s[20:23], s49 offen lds
  v_mul_f32 v31, 0xb5000000, v23
  s_waitcnt vmcnt(10)
  v_fma_mix_f32 v160, v160, v20, v28 op_sel_hi:[1,0,0]
  v_fma_mix_f32 v161, v161, v21, v29 op_sel_hi:[1,0,0]
  v_fma_mix_f32 v162, v162, v22, v30 op_sel_hi:[1,0,0]
  v_fma_mix_f32 v163, v163, v23, v31 op_sel_hi:[1,0,0]
  s_add_u32 m0, s8, 132096
  s_nop 0
  buffer_load_dwordx4 v3, s[20:23], s50 offen lds
  s_waitcnt vmcnt(10)
  v_fma_mix_f32 v164, v164, v20, v28 op_sel_hi:[1,0,0]
  v_fma_mix_f32 v165, v165, v21, v29 op_sel_hi:[1,0,0]
  v_fma_mix_f32 v166, v166, v22, v30 op_sel_hi:[1,0,0]
  v_fma_mix_f32 v167, v167, v23, v31 op_sel_hi:[1,0,0]
  v_cvt_pk_bf16_f32 v32, v160, v164
  s_add_u32 m0, s8, 136192
  s_nop 0
  buffer_load_dwordx4 v3, s[20:23], s51 offen lds
  v_cvt_pk_bf16_f32 v36, v161, v165
  v_cvt_pk_bf16_f32 v40, v162, v166
  v_cvt_pk_bf16_f32 v44, v163, v167
  s_waitcnt vmcnt(10)
  v_fma_mix_f32 v168, v168, v20, v28 op_sel_hi:[1,0,0]
  v_fma_mix_f32 v169, v169, v21, v29 op_sel_hi:[1,0,0]
  s_add_u32 m0, s8, 140288
  s_nop 0
  buffer_load_dwordx4 v3, s[20:23], s52 offen lds
  v_fma_mix_f32 v170, v170, v22, v30 op_sel_hi:[1,0,0]
  v_fma_mix_f32 v171, v171, v23, v31 op_sel_hi:[1,0,0]
  s_waitcnt vmcnt(10)
  v_fma_mix_f32 v172, v172, v20, v28 op_sel_hi:[1,0,0]
  v_fma_mix_f32 v173, v173, v21, v29 op_sel_hi:[1,0,0]
  v_fma_mix_f32 v174, v174, v22, v30 op_sel_hi:[1,0,0]
  s_add_u32 m0, s8, 144384
  s_nop 0
  buffer_load_dwordx4 v3, s[20:23], s53 offen lds
  v_fma_mix_f32 v175, v175, v23, v31 op_sel_hi:[1,0,0]
  v_cvt_pk_bf16_f32 v33, v168, v172
  v_cvt_pk_bf16_f32 v37, v169, v173
  v_cvt_pk_bf16_f32 v41, v170, v174
  v_cvt_pk_bf16_f32 v45, v171, v175
  s_add_u32 m0, s8, 148480
  s_nop 0
L_w3a:
  s_cbranch_execz L_wret1a
  buffer_load_dwordx4 v3, s[20:23], s54 offen lds
  s_waitcnt vmcnt(11)
  v_fma_mix_f32 v176, v176, v20, v28 op_sel_hi:[1,0,0]
  v_fma_mix_f32 v177, v177, v21, v29 op_sel_hi:[1,0,0]
  v_fma_mix_f32 v178, v178, v22, v30 op_sel_hi:[1,0,0]
  v_fma_mix_f32 v179, v179, v23, v31 op_sel_hi:[1,0,0]
  s_waitcnt vmcnt(10)
  v_fma_mix_f32 v180, v180, v20, v28 op_sel_hi:[1,0,0]
  s_add_u32 m0, s8, 152576
  s_nop 0
  buffer_load_dwordx4 v3, s[20:23], s55 offen lds
  v_fma_mix_f32 v181, v181, v21, v29 op_sel_hi:[1,0,0]
  v_fma_mix_f32 v182, v182, v22, v30 op_sel_hi:[1,0,0]
  v_fma_mix_f32 v183, v183, v23, v31 op_sel_hi:[1,0,0]
  v_cvt_pk_bf16_f32 v34, v176, v180
  v_cvt_pk_bf16_f32 v38, v177, v181
  v_lshl_add_u32 v1, s65, 7, v1
  s_add_u32 m0, s9, 156672
  s_nop 0
  s_mov_b32 exec_hi, 0
  buffer_load_dwordx4 v1, s[20:23], 0 offen lds
  s_mov_b32 exec_hi, -1
  v_cvt_pk_bf16_f32 v42, v178, v182
  v_cvt_pk_bf16_f32 v46, v179, v183
  s_waitcnt vmcnt(11)
  v_fma_mix_f32 v184, v184, v20, v28 op_sel_hi:[1,0,0]
  v_fma_mix_f32 v185, v185, v21, v29 op_sel_hi:[1,0,0]
  v_fma_mix_f32 v186, v186, v22, v30 op_sel_hi:[1,0,0]
  v_lshl_add_u32 v2, s58, 17, v2
  buffer_load_dwordx4 v[96:99], v2, s[24:27], 0 offen
  v_fma_mix_f32 v187, v187, v23, v31 op_sel_hi:[1,0,0]
  s_waitcnt vmcnt(11)
  v_fma_mix_f32 v188, v188, v20, v28 op_sel_hi:[1,0,0]
  v_fma_mix_f32 v189, v189, v21, v29 op_sel_hi:[1,0,0]
  v_fma_mix_f32 v190, v190, v22, v30 op_sel_hi:[1,0,0]
  v_fma_mix_f32 v191, v191, v23, v31 op_sel_hi:[1,0,0]
  buffer_load_dwordx4 v[100:103], v2, s[24:27], s41 offen
  v_cvt_pk_bf16_f32 v35, v184, v188
  v_cvt_pk_bf16_f32 v39, v185, v189
  v_cvt_pk_bf16_f32 v43, v186, v190
  v_cvt_pk_bf16_f32 v47, v187, v191
  ds_read_b128 v[24:27], v5 offset:768
  ds_write_b128 v7, v[32:35] offset:0
  buffer_load_dwordx4 v[104:107], v2, s[24:27], s42 offen
  ds_write_b128 v7, v[36:39] offset:1024
  buffer_load_dwordx4 v[108:111], v2, s[24:27], s43 offen
  ds_write_b128 v7, v[40:43] offset:2048
  buffer_load_dwordx4 v[112:115], v2, s[24:27], s44 offen
  ds_write_b128 v7, v[44:47] offset:3072
  buffer_load_dwordx4 v[116:119], v2, s[24:27], s45 offen
  buffer_load_dwordx4 v[120:123], v2, s[24:27], s46 offen
  buffer_load_dwordx4 v[124:127], v2, s[24:27], s47 offen
  v_lshl_add_u32 v3, s66, 7, v3
  s_add_u32 m0, s8, 41984
  s_nop 0
  buffer_load_dwordx4 v3, s[20:23], 0 offen lds
  s_add_u32 m0, s8, 46080
  s_nop 0
  buffer_load_dwordx4 v3, s[20:23], s48 offen lds
  s_add_u32 m0, s8, 50176
  s_nop 0
  buffer_load_dwordx4 v3, s[20:23], s49 offen lds
  s_add_u32 m0, s8, 54272
  s_nop 0
  buffer_load_dwordx4 v3, s[20:23], s50 offen lds
  s_add_u32 m0, s8, 58368
  s_nop 0
  buffer_load_dwordx4 v3, s[20:23], s51 offen lds
  s_add_u32 m0, s8, 62464
  s_nop 0
  buffer_load_dwordx4 v3, s[20:23], s52 offen lds
  s_waitcnt lgkmcnt(4)
  v_mul_f32 v28, 0xb5000000, v24
  s_waitcnt vmcnt(14) lgkmcnt(0)
  s_barrier
  v_mul_f32 v29, 0xb5000000, v25
  v_mul_f32 v30, 0xb5000000, v26
  s_add_u32 m0, s8, 66560
  s_nop 0
  buffer_load_dwordx4 v3, s[20:23], s53 offen lds
  v_mul_f32 v31, 0xb5000000, v27
  s_waitcnt vmcnt(14)
  v_fma_mix_f32 v96, v96, v24, v28 op_sel_hi:[1,0,0]
  v_fma_mix_f32 v97, v97, v25, v29 op_sel_hi:[1,0,0]
  v_fma_mix_f32 v98, v98, v26, v30 op_sel_hi:[1,0,0]
  v_fma_mix_f32 v99, v99, v27, v31 op_sel_hi:[1,0,0]
  s_add_u32 m0, s8, 70656
  s_nop 0
  buffer_load_dwordx4 v3, s[20:23], s54 offen lds
  s_waitcnt vmcnt(14)
  v_fma_mix_f32 v100, v100, v24, v28 op_sel_hi:[1,0,0]
  v_fma_mix_f32 v101, v101, v25, v29 op_sel_hi:[1,0,0]
  v_fma_mix_f32 v102, v102, v26, v30 op_sel_hi:[1,0,0]
  v_fma_mix_f32 v103, v103, v27, v31 op_sel_hi:[1,0,0]
  v_cvt_pk_bf16_f32 v48, v96, v100
  s_add_u32 m0, s8, 74752
  s_nop 0
  buffer_load_dwordx4 v3, s[20:23], s55 offen lds
  v_cvt_pk_bf16_f32 v52, v97, v101
  v_cvt_pk_bf16_f32 v56, v98, v102
  v_cvt_pk_bf16_f32 v60, v99, v103
  s_waitcnt vmcnt(14)
  v_fma_mix_f32 v104, v104, v24, v28 op_sel_hi:[1,0,0]
  v_fma_mix_f32 v105, v105, v25, v29 op_sel_hi:[1,0,0]
  v_lshl_add_u32 v1, s66, 7, v1
  s_add_u32 m0, s9, 78848
  s_nop 0
  s_mov_b32 exec_hi, 0
  buffer_load_dwordx4 v1, s[20:23], 0 offen lds
  s_mov_b32 exec_hi, -1
  v_fma_mix_f32 v106, v106, v26, v30 op_sel_hi:[1,0,0]
  v_fma_mix_f32 v107, v107, v27, v31 op_sel_hi:[1,0,0]
  s_waitcnt vmcnt(14)
  v_fma_mix_f32 v108, v108, v24, v28 op_sel_hi:[1,0,0]
  v_fma_mix_f32 v109, v109, v25, v29 op_sel_hi:[1,0,0]
  v_fma_mix_f32 v110, v110, v26, v30 op_sel_hi:[1,0,0]
  v_lshl_add_u32 v2, s59, 17, v2
  buffer_load_dwordx4 v[128:131], v2, s[24:27], 0 offen
  v_fma_mix_f32 v111, v111, v27, v31 op_sel_hi:[1,0,0]
  v_cvt_pk_bf16_f32 v49, v104, v108
  v_cvt_pk_bf16_f32 v53, v105, v109
  v_cvt_pk_bf16_f32 v57, v106, v110
  v_cvt_pk_bf16_f32 v61, v107, v111
  buffer_load_dwordx4 v[132:135], v2, s[24:27], s41 offen
  s_waitcnt vmcnt(15)
  v_fma_mix_f32 v112, v112, v24, v28 op_sel_hi:[1,0,0]
  v_fma_mix_f32 v113, v113, v25, v29 op_sel_hi:[1,0,0]
  v_fma_mix_f32 v114, v114, v26, v30 op_sel_hi:[1,0,0]
  v_fma_mix_f32 v115, v115, v27, v31 op_sel_hi:[1,0,0]
  s_waitcnt vmcnt(14)
  v_fma_mix_f32 v116, v116, v24, v28 op_sel_hi:[1,0,0]
  buffer_load_dwordx4 v[136:139], v2, s[24:27], s42 offen
  v_fma_mix_f32 v117, v117, v25, v29 op_sel_hi:[1,0,0]
  v_fma_mix_f32 v118, v118, v26, v30 op_sel_hi:[1,0,0]
  v_fma_mix_f32 v119, v119, v27, v31 op_sel_hi:[1,0,0]
  v_cvt_pk_bf16_f32 v50, v112, v116
  v_cvt_pk_bf16_f32 v54, v113, v117
  buffer_load_dwordx4 v[140:143], v2, s[24:27], s43 offen
  v_cvt_pk_bf16_f32 v58, v114, v118
  v_cvt_pk_bf16_f32 v62, v115, v119
  s_waitcnt vmcnt(15)
  v_fma_mix_f32 v120, v120, v24, v28 op_sel_hi:[1,0,0]
  v_fma_mix_f32 v121, v121, v25, v29 op_sel_hi:[1,0,0]
  v_fma_mix_f32 v122, v122, v26, v30 op_sel_hi:[1,0,0]
  buffer_load_dwordx4 v[144:147], v2, s[24:27], s44 offen
  v_fma_mix_f32 v123, v123, v27, v31 op_sel_hi:[1,0,0]
  s_waitcnt vmcnt(15)
  v_fma_mix_f32 v124, v124, v24, v28 op_sel_hi:[1,0,0]
  v_fma_mix_f32 v125, v125, v25, v29 op_sel_hi:[1,0,0]
  v_fma_mix_f32 v126, v126, v26, v30 op_sel_hi:[1,0,0]
  v_fma_mix_f32 v127, v127, v27, v31 op_sel_hi:[1,0,0]
  buffer_load_dwordx4 v[148:151], v2, s[24:27], s45 offen
  v_cvt_pk_bf16_f32 v51, v120, v124
  v_cvt_pk_bf16_f32 v55, v121, v125
  v_cvt_pk_bf16_f32 v59, v122, v126
  v_cvt_pk_bf16_f32 v63, v123, v127
  ds_read_b128 v[20:23], v5 offset:1024
  ds_write_b128 v7, v[48:51] offset:16384
  buffer_load_dwordx4 v[152:155], v2, s[24:27], s46 offen
  ds_write_b128 v7, v[52:55] offset:17408
  buffer_load_dwordx4 v[156:159], v2, s[24:27], s47 offen
  ds_write_b128 v7, v[56:59] offset:18432
  v_lshl_add_u32 v3, s67, 7, v3
  s_add_u32 m0, s8, 80896
  s_nop 0
  buffer_load_dwordx4 v3, s[20:23], 0 offen lds
  ds_write_b128 v7, v[60:63] offset:19456
  s_add_u32 m0, s8, 84992
  s_nop 0
  buffer_load_dwordx4 v3, s[20:23], s48 offen lds
  s_add_u32 m0, s8, 89088
  s_nop 0
  buffer_load_dwordx4 v3, s[20:23], s49 offen lds
  s_add_u32 m0, s8, 93184
  s_nop 0
  buffer_load_dwordx4 v3, s[20:23], s50 offen lds
  s_add_u32 m0, s8, 97280
  s_nop 0
  buffer_load_dwordx4 v3, s[20:23], s51 offen lds
  s_add_u32 m0, s8, 101376
  s_nop 0
  buffer_load_dwordx4 v3, s[20:23], s52 offen lds
  s_add_u32 m0, s8, 105472
  s_nop 0
  buffer_load_dwordx4 v3, s[20:23], s53 offen lds
  s_waitcnt lgkmcnt(4)
  v_mul_f32 v28, 0xb5000000, v20
  v_mul_f32 v29, 0xb5000000, v21
  v_mul_f32 v30, 0xb5000000, v22
  s_add_u32 m0, s8, 109568
  s_nop 0
  buffer_load_dwordx4 v3, s[20:23], s54 offen lds
  v_mul_f32 v31, 0xb5000000, v23
  s_waitcnt vmcnt(15)
  v_fma_mix_f32 v128, v128, v20, v28 op_sel_hi:[1,0,0]
  v_fma_mix_f32 v129, v129, v21, v29 op_sel_hi:[1,0,0]
  s_waitcnt lgkmcnt(0)
  s_barrier
  v_fma_mix_f32 v130, v130, v22, v30 op_sel_hi:[1,0,0]
  v_fma_mix_f32 v131, v131, v23, v31 op_sel_hi:[1,0,0]
  s_add_u32 m0, s8, 113664
  s_nop 0
  buffer_load_dwordx4 v3, s[20:23], s55 offen lds
  s_waitcnt vmcnt(15)
  v_fma_mix_f32 v132, v132, v20, v28 op_sel_hi:[1,0,0]
  v_fma_mix_f32 v133, v133, v21, v29 op_sel_hi:[1,0,0]
  v_fma_mix_f32 v134, v134, v22, v30 op_sel_hi:[1,0,0]
  v_fma_mix_f32 v135, v135, v23, v31 op_sel_hi:[1,0,0]
  v_cvt_pk_bf16_f32 v32, v128, v132
  v_lshl_add_u32 v1, s67, 7, v1
  s_add_u32 m0, s9, 117760
  s_nop 0
  s_mov_b32 exec_hi, 0
  buffer_load_dwordx4 v1, s[20:23], 0 offen lds
  s_mov_b32 exec_hi, -1
  v_cvt_pk_bf16_f32 v36, v129, v133
  v_cvt_pk_bf16_f32 v40, v130, v134
  v_cvt_pk_bf16_f32 v44, v131, v135
  s_waitcnt vmcnt(15)
  v_fma_mix_f32 v136, v136, v20, v28 op_sel_hi:[1,0,0]
  v_fma_mix_f32 v137, v137, v21, v29 op_sel_hi:[1,0,0]
  v_lshl_add_u32 v2, s60, 17, v2
  buffer_load_dwordx4 v[160:163], v2, s[24:27], 0 offen
  v_fma_mix_f32 v138, v138, v22, v30 op_sel_hi:[1,0,0]
  v_fma_mix_f32 v139, v139, v23, v31 op_sel_hi:[1,0,0]
  s_waitcnt vmcnt(15)
  v_fma_mix_f32 v140, v140, v20, v28 op_sel_hi:[1,0,0]
  v_fma_mix_f32 v141, v141, v21, v29 op_sel_hi:[1,0,0]
  v_fma_mix_f32 v142, v142, v22, v30 op_sel_hi:[1,0,0]
  buffer_load_dwordx4 v[164:167], v2, s[24:27], s41 offen
  v_fma_mix_f32 v143, v143, v23, v31 op_sel_hi:[1,0,0]
  v_cvt_pk_bf16_f32 v33, v136, v140
  v_cvt_pk_bf16_f32 v37, v137, v141
  v_cvt_pk_bf16_f32 v41, v138, v142
  v_cvt_pk_bf16_f32 v45, v139, v143
  buffer_load_dwordx4 v[168:171], v2, s[24:27], s42 offen
  s_waitcnt vmcnt(16)
  v_fma_mix_f32 v144, v144, v20, v28 op_sel_hi:[1,0,0]
  v_fma_mix_f32 v145, v145, v21, v29 op_sel_hi:[1,0,0]
  v_fma_mix_f32 v146, v146, v22, v30 op_sel_hi:[1,0,0]
  v_fma_mix_f32 v147, v147, v23, v31 op_sel_hi:[1,0,0]
  s_waitcnt vmcnt(15)
  v_fma_mix_f32 v148, v148, v20, v28 op_sel_hi:[1,0,0]
  buffer_load_dwordx4 v[172:175], v2, s[24:27], s43 offen
  v_fma_mix_f32 v149, v149, v21, v29 op_sel_hi:[1,0,0]
  v_fma_mix_f32 v150, v150, v22, v30 op_sel_hi:[1,0,0]
  v_fma_mix_f32 v151, v151, v23, v31 op_sel_hi:[1,0,0]
  v_cvt_pk_bf16_f32 v34, v144, v148
  v_cvt_pk_bf16_f32 v38, v145, v149
  buffer_load_dwordx4 v[176:179], v2, s[24:27], s44 offen
  v_cvt_pk_bf16_f32 v42, v146, v150
  v_cvt_pk_bf16_f32 v46, v147, v151
  s_waitcnt vmcnt(16)
  v_fma_mix_f32 v152, v152, v20, v28 op_sel_hi:[1,0,0]
  v_fma_mix_f32 v153, v153, v21, v29 op_sel_hi:[1,0,0]
  v_fma_mix_f32 v154, v154, v22, v30 op_sel_hi:[1,0,0]
  buffer_load_dwordx4 v[180:183], v2, s[24:27], s45 offen
  v_fma_mix_f32 v155, v155, v23, v31 op_sel_hi:[1,0,0]
  s_waitcnt vmcnt(16)
  v_fma_mix_f32 v156, v156, v20, v28 op_sel_hi:[1,0,0]
  v_fma_mix_f32 v157, v157, v21, v29 op_sel_hi:[1,0,0]
  v_fma_mix_f32 v158, v158, v22, v30 op_sel_hi:[1,0,0]
  v_fma_mix_f32 v159, v159, v23, v31 op_sel_hi:[1,0,0]
  buffer_load_dwordx4 v[184:187], v2, s[24:27], s46 offen
  v_cvt_pk_bf16_f32 v35, v152, v156
  v_cvt_pk_bf16_f32 v39, v153, v157
  v_cvt_pk_bf16_f32 v43, v154, v158
  v_cvt_pk_bf16_f32 v47, v155, v159
  ds_read_b128 v[24:27], v5 offset:1280
  ds_write_b128 v7, v[32:35] offset:0
  buffer_load_dwordx4 v[188:191], v2, s[24:27], s47 offen
  ds_write_b128 v7, v[36:39] offset:1024
  v_lshl_add_u32 v3, s68, 7, v3
  s_add_u32 m0, s8, 119808
  s_nop 0
  buffer_load_dwordx4 v3, s[20:23], 0 offen lds
  ds_write_b128 v7, v[40:43] offset:2048
  s_add_u32 m0, s8, 123904
  s_nop 0
  buffer_load_dwordx4 v3, s[20:23], s48 offen lds
  ds_write_b128 v7, v[44:47] offset:3072
  s_add_u32 m0, s8, 128000
  s_nop 0
  buffer_load_dwordx4 v3, s[20:23], s49 offen lds
  s_add_u32 m0, s8, 132096
  s_nop 0
  buffer_load_dwordx4 v3, s[20:23], s50 offen lds
  s_add_u32 m0, s8, 136192
  s_nop 0
  buffer_load_dwordx4 v3, s[20:23], s51 offen lds
  s_add_u32 m0, s8, 140288
  s_nop 0
  buffer_load_dwordx4 v3, s[20:23], s52 offen lds
  s_add_u32 m0, s8, 144384
  s_nop 0
  buffer_load_dwordx4 v3, s[20:23], s53 offen lds
  s_waitcnt lgkmcnt(4)
  v_mul_f32 v28, 0xb5000000, v24
  v_mul_f32 v29, 0xb5000000, v25
  v_mul_f32 v30, 0xb5000000, v26
  s_add_u32 m0, s8, 148480
  s_nop 0
  buffer_load_dwordx4 v3, s[20:23], s54 offen lds
  v_mul_f32 v31, 0xb5000000, v27
  s_waitcnt vmcnt(15)
  v_fma_mix_f32 v160, v160, v24, v28 op_sel_hi:[1,0,0]
  v_fma_mix_f32 v161, v161, v25, v29 op_sel_hi:[1,0,0]
  s_waitcnt lgkmcnt(0)
  s_barrier
  v_fma_mix_f32 v162, v162, v26, v30 op_sel_hi:[1,0,0]
  v_fma_mix_f32 v163, v163, v27, v31 op_sel_hi:[1,0,0]
  s_add_u32 m0, s8, 152576
  s_nop 0
  buffer_load_dwordx4 v3, s[20:23], s55 offen lds
  s_waitcnt vmcnt(15)
  v_fma_mix_f32 v164, v164, v24, v28 op_sel_hi:[1,0,0]
  v_fma_mix_f32 v165, v165, v25, v29 op_sel_hi:[1,0,0]
  v_fma_mix_f32 v166, v166, v26, v30 op_sel_hi:[1,0,0]
  v_fma_mix_f32 v167, v167, v27, v31 op_sel_hi:[1,0,0]
  v_cvt_pk_bf16_f32 v48, v160, v164
  v_lshl_add_u32 v1, s68, 7, v1
  s_add_u32 m0, s9, 156672
  s_nop 0
  s_mov_b32 exec_hi, 0
  buffer_load_dwordx4 v1, s[20:23], 0 offen lds
  s_mov_b32 exec_hi, -1
  v_cvt_pk_bf16_f32 v52, v161, v165
  v_cvt_pk_bf16_f32 v56, v162, v166
  v_cvt_pk_bf16_f32 v60, v163, v167
  s_waitcnt vmcnt(15)
  v_fma_mix_f32 v168, v168, v24, v28 op_sel_hi:[1,0,0]
  v_fma_mix_f32 v169, v169, v25, v29 op_sel_hi:[1,0,0]
  v_lshl_add_u32 v2, s61, 17, v2
  buffer_load_dwordx4 v[96:99], v2, s[24:27], 0 offen
  v_fma_mix_f32 v170, v170, v26, v30 op_sel_hi:[1,0,0]
  v_fma_mix_f32 v171, v171, v27, v31 op_sel_hi:[1,0,0]
  s_waitcnt vmcnt(15)
  v_fma_mix_f32 v172, v172, v24, v28 op_sel_hi:[1,0,0]
  v_fma_mix_f32 v173, v173, v25, v29 op_sel_hi:[1,0,0]
  v_fma_mix_f32 v174, v174, v26, v30 op_sel_hi:[1,0,0]
  buffer_load_dwordx4 v[100:103], v2, s[24:27], s41 offen
  v_fma_mix_f32 v175, v175, v27, v31 op_sel_hi:[1,0,0]
  v_cvt_pk_bf16_f32 v49, v168, v172
  v_cvt_pk_bf16_f32 v53, v169, v173
  v_cvt_pk_bf16_f32 v57, v170, v174
  v_cvt_pk_bf16_f32 v61, v171, v175
  buffer_load_dwordx4 v[104:107], v2, s[24:27], s42 offen
  s_waitcnt vmcnt(16)
  v_fma_mix_f32 v176, v176, v24, v28 op_sel_hi:[1,0,0]
  v_fma_mix_f32 v177, v177, v25, v29 op_sel_hi:[1,0,0]
  v_fma_mix_f32 v178, v178, v26, v30 op_sel_hi:[1,0,0]
  v_fma_mix_f32 v179, v179, v27, v31 op_sel_hi:[1,0,0]
  s_waitcnt vmcnt(15)
  v_fma_mix_f32 v180, v180, v24, v28 op_sel_hi:[1,0,0]
  buffer_load_dwordx4 v[108:111], v2, s[24:27], s43 offen
  v_fma_mix_f32 v181, v181, v25, v29 op_sel_hi:[1,0,0]
  v_fma_mix_f32 v182, v182, v26, v30 op_sel_hi:[1,0,0]
  v_fma_mix_f32 v183, v183, v27, v31 op_sel_hi:[1,0,0]
  v_cvt_pk_bf16_f32 v50, v176, v180
  v_cvt_pk_bf16_f32 v54, v177, v181
  buffer_load_dwordx4 v[112:115], v2, s[24:27], s44 offen
  v_cvt_pk_bf16_f32 v58, v178, v182
  v_cvt_pk_bf16_f32 v62, v179, v183
  s_waitcnt vmcnt(16)
  v_fma_mix_f32 v184, v184, v24, v28 op_sel_hi:[1,0,0]
  v_fma_mix_f32 v185, v185, v25, v29 op_sel_hi:[1,0,0]
  v_fma_mix_f32 v186, v186, v26, v30 op_sel_hi:[1,0,0]
  buffer_load_dwordx4 v[116:119], v2, s[24:27], s45 offen
  v_fma_mix_f32 v187, v187, v27, v31 op_sel_hi:[1,0,0]
  s_waitcnt vmcnt(16)
  v_fma_mix_f32 v188, v188, v24, v28 op_sel_hi:[1,0,0]
  v_fma_mix_f32 v189, v189, v25, v29 op_sel_hi:[1,0,0]
  v_fma_mix_f32 v190, v190, v26, v30 op_sel_hi:[1,0,0]
  v_fma_mix_f32 v191, v191, v27, v31 op_sel_hi:[1,0,0]
  buffer_load_dwordx4 v[120:123], v2, s[24:27], s46 offen
  v_cvt_pk_bf16_f32 v51, v184, v188
  v_cvt_pk_bf16_f32 v55, v185, v189
  v_cvt_pk_bf16_f32 v59, v186, v190
  v_cvt_pk_bf16_f32 v63, v187, v191
  ds_read_b128 v[20:23], v5 offset:1536
  ds_write_b128 v7, v[48:51] offset:16384
  buffer_load_dwordx4 v[124:127], v2, s[24:27], s47 offen
  ds_write_b128 v7, v[52:55] offset:17408
  v_lshl_add_u32 v3, s69, 7, v3
  s_add_u32 m0, s8, 41984
  s_nop 0
  buffer_load_dwordx4 v3, s[20:23], 0 offen lds
  ds_write_b128 v7, v[56:59] offset:18432
  s_add_u32 m0, s8, 46080
  s_nop 0
  buffer_load_dwordx4 v3, s[20:23], s48 offen lds
  ds_write_b128 v7, v[60:63] offset:19456
  s_add_u32 m0, s8, 50176
  s_nop 0
  buffer_load_dwordx4 v3, s[20:23], s49 offen lds
  s_add_u32 m0, s8, 54272
  s_nop 0
  buffer_load_dwordx4 v3, s[20:23], s50 offen lds
  v_lshl_add_u32 v2, s62, 17, v2
  buffer_load_dwordx4 v[128:131], v2, s[24:27], 0 offen
  buffer_load_dwordx4 v[132:135], v2, s[24:27], s41 offen
  buffer_load_dwordx4 v[136:139], v2, s[24:27], s42 offen
  s_waitcnt lgkmcnt(4)
  v_mul_f32 v28, 0xb5000000, v20
  v_mul_f32 v29, 0xb5000000, v21
  v_mul_f32 v30, 0xb5000000, v22
  v_mul_f32 v31, 0xb5000000, v23
  s_waitcnt vmcnt(14)
  v_fma_mix_f32 v96, v96, v20, v28 op_sel_hi:[1,0,0]
  buffer_load_dwordx4 v[140:143], v2, s[24:27], s43 offen
  v_fma_mix_f32 v97, v97, v21, v29 op_sel_hi:[1,0,0]
  v_fma_mix_f32 v98, v98, v22, v30 op_sel_hi:[1,0,0]
  v_fma_mix_f32 v99, v99, v23, v31 op_sel_hi:[1,0,0]
  s_waitcnt vmcnt(14)
  v_fma_mix_f32 v100, v100, v20, v28 op_sel_hi:[1,0,0]
  v_fma_mix_f32 v101, v101, v21, v29 op_sel_hi:[1,0,0]
  v_fma_mix_f32 v102, v102, v22, v30 op_sel_hi:[1,0,0]
  s_waitcnt lgkmcnt(0)
  s_barrier
  v_fma_mix_f32 v103, v103, v23, v31 op_sel_hi:[1,0,0]
  v_cvt_pk_bf16_f32 v32, v96, v100
  v_cvt_pk_bf16_f32 v36, v97, v101
  v_cvt_pk_bf16_f32 v40, v98, v102
  buffer_load_dwordx4 v[144:147], v2, s[24:27], s44 offen
  v_cvt_pk_bf16_f32 v44, v99, v103
  s_waitcnt vmcnt(14)
  v_fma_mix_f32 v104, v104, v20, v28 op_sel_hi:[1,0,0]
  v_fma_mix_f32 v105, v105, v21, v29 op_sel_hi:[1,0,0]
  v_fma_mix_f32 v106, v106, v22, v30 op_sel_hi:[1,0,0]
  v_fma_mix_f32 v107, v107, v23, v31 op_sel_hi:[1,0,0]
  s_waitcnt vmcnt(13)
  v_fma_mix_f32 v108, v108, v20, v28 op_sel_hi:[1,0,0]
  v_fma_mix_f32 v109, v109, v21, v29 op_sel_hi:[1,0,0]
  v_fma_mix_f32 v110, v110, v22, v30 op_sel_hi:[1,0,0]
  v_fma_mix_f32 v111, v111, v23, v31 op_sel_hi:[1,0,0]
  v_cvt_pk_bf16_f32 v33, v104, v108
  buffer_load_dwordx4 v[148:151], v2, s[24:27], s45 offen
  v_cvt_pk_bf16_f32 v37, v105, v109
  v_cvt_pk_bf16_f32 v41, v106, v110
  v_cvt_pk_bf16_f32 v45, v107, v111
  s_waitcnt vmcnt(13)
  v_fma_mix_f32 v112, v112, v20, v28 op_sel_hi:[1,0,0]
  v_fma_mix_f32 v113, v113, v21, v29 op_sel_hi:[1,0,0]
  v_fma_mix_f32 v114, v114, v22, v30 op_sel_hi:[1,0,0]
  v_fma_mix_f32 v115, v115, v23, v31 op_sel_hi:[1,0,0]
  s_waitcnt vmcnt(12)
  v_fma_mix_f32 v116, v116, v20, v28 op_sel_hi:[1,0,0]
  v_fma_mix_f32 v117, v117, v21, v29 op_sel_hi:[1,0,0]
  v_fma_mix_f32 v118, v118, v22, v30 op_sel_hi:[1,0,0]
  buffer_load_dwordx4 v[152:155], v2, s[24:27], s46 offen
  v_fma_mix_f32 v119, v119, v23, v31 op_sel_hi:[1,0,0]
  v_cvt_pk_bf16_f32 v34, v112, v116
  v_cvt_pk_bf16_f32 v38, v113, v117
  v_cvt_pk_bf16_f32 v42, v114, v118
  v_cvt_pk_bf16_f32 v46, v115, v119
  s_waitcnt vmcnt(12)
  v_fma_mix_f32 v120, v120, v20, v28 op_sel_hi:[1,0,0]
  v_fma_mix_f32 v121, v121, v21, v29 op_sel_hi:[1,0,0]
  v_fma_mix_f32 v122, v122, v22, v30 op_sel_hi:[1,0,0]
  v_fma_mix_f32 v123, v123, v23, v31 op_sel_hi:[1,0,0]
  s_waitcnt vmcnt(11)
  v_fma_mix_f32 v124, v124, v20, v28 op_sel_hi:[1,0,0]
  buffer_load_dwordx4 v[156:159], v2, s[24:27], s47 offen
  v_fma_mix_f32 v125, v125, v21, v29 op_sel_hi:[1,0,0]
  v_fma_mix_f32 v126, v126, v22, v30 op_sel_hi:[1,0,0]
  v_fma_mix_f32 v127, v127, v23, v31 op_sel_hi:[1,0,0]
  v_cvt_pk_bf16_f32 v35, v120, v124
  v_cvt_pk_bf16_f32 v39, v121, v125
  v_cvt_pk_bf16_f32 v43, v122, v126
  v_cvt_pk_bf16_f32 v47, v123, v127
  ds_read_b128 v[24:27], v5 offset:1792
  ds_write_b128 v7, v[32:35] offset:0
  v_lshl_add_u32 v19, s70, 7, v3
  s_add_u32 m0, s8, 80896
  s_nop 0
  buffer_load_dwordx4 v19, s[20:23], 0 offen lds
  ds_write_b128 v7, v[36:39] offset:1024
  ds_write_b128 v7, v[40:43] offset:2048
  s_add_u32 m0, s8, 84992
  s_nop 0
  buffer_load_dwordx4 v19, s[20:23], s48 offen lds
  ds_write_b128 v7, v[44:47] offset:3072
  s_add_u32 m0, s8, 89088
  s_nop 0
  buffer_load_dwordx4 v19, s[20:23], s49 offen lds
  s_waitcnt lgkmcnt(4)
  v_mul_f32 v28, 0xb5000000, v24
  v_mul_f32 v29, 0xb5000000, v25
  v_mul_f32 v30, 0xb5000000, v26
  v_mul_f32 v31, 0xb5000000, v27
  s_waitcnt vmcnt(10)
  v_fma_mix_f32 v128, v128, v24, v28 op_sel_hi:[1,0,0]
  s_add_u32 m0, s8, 93184
  s_nop 0
  buffer_load_dwordx4 v19, s[20:23], s50 offen lds
  v_fma_mix_f32 v129, v129, v25, v29 op_sel_hi:[1,0,0]
  v_fma_mix_f32 v130, v130, v26, v30 op_sel_hi:[1,0,0]
  v_fma_mix_f32 v131, v131, v27, v31 op_sel_hi:[1,0,0]
  s_waitcnt vmcnt(10)
  v_fma_mix_f32 v132, v132, v24, v28 op_sel_hi:[1,0,0]
  v_fma_mix_f32 v133, v133, v25, v29 op_sel_hi:[1,0,0]
  v_fma_mix_f32 v134, v134, v26, v30 op_sel_hi:[1,0,0]
  v_fma_mix_f32 v135, v135, v27, v31 op_sel_hi:[1,0,0]
  v_cvt_pk_bf16_f32 v48, v128, v132
  v_lshl_add_u32 v2, s63, 17, v2
  buffer_load_dwordx4 v[160:163], v2, s[24:27], 0 offen
  v_cvt_pk_bf16_f32 v52, v129, v133
  v_cvt_pk_bf16_f32 v56, v130, v134
  v_cvt_pk_bf16_f32 v60, v131, v135
  s_waitcnt vmcnt(10)
  v_fma_mix_f32 v136, v136, v24, v28 op_sel_hi:[1,0,0]
  v_fma_mix_f32 v137, v137, v25, v29 op_sel_hi:[1,0,0]
  v_fma_mix_f32 v138, v138, v26, v30 op_sel_hi:[1,0,0]
  v_fma_mix_f32 v139, v139, v27, v31 op_sel_hi:[1,0,0]
  s_waitcnt vmcnt(9)
  v_fma_mix_f32 v140, v140, v24, v28 op_sel_hi:[1,0,0]
  buffer_load_dwordx4 v[164:167], v2, s[24:27], s41 offen
  v_fma_mix_f32 v141, v141, v25, v29 op_sel_hi:[1,0,0]
  v_fma_mix_f32 v142, v142, v26, v30 op_sel_hi:[1,0,0]
  v_fma_mix_f32 v143, v143, v27, v31 op_sel_hi:[1,0,0]
  v_cvt_pk_bf16_f32 v49, v136, v140
  v_cvt_pk_bf16_f32 v53, v137, v141
  v_cvt_pk_bf16_f32 v57, v138, v142
  v_cvt_pk_bf16_f32 v61, v139, v143
  s_waitcnt vmcnt(9)
  v_fma_mix_f32 v144, v144, v24, v28 op_sel_hi:[1,0,0]
  v_fma_mix_f32 v145, v145, v25, v29 op_sel_hi:[1,0,0]
  buffer_load_dwordx4 v[168:171], v2, s[24:27], s42 offen
  v_fma_mix_f32 v146, v146, v26, v30 op_sel_hi:[1,0,0]
  v_fma_mix_f32 v147, v147, v27, v31 op_sel_hi:[1,0,0]
  s_waitcnt vmcnt(9)
  v_fma_mix_f32 v148, v148, v24, v28 op_sel_hi:[1,0,0]
  v_fma_mix_f32 v149, v149, v25, v29 op_sel_hi:[1,0,0]
  v_fma_mix_f32 v150, v150, v26, v30 op_sel_hi:[1,0,0]
  v_fma_mix_f32 v151, v151, v27, v31 op_sel_hi:[1,0,0]
  v_cvt_pk_bf16_f32 v50, v144, v148
  v_cvt_pk_bf16_f32 v54, v145, v149
  buffer_load_dwordx4 v[172:175], v2, s[24:27], s43 offen
  v_cvt_pk_bf16_f32 v58, v146, v150
  v_cvt_pk_bf16_f32 v62, v147, v151
  s_waitcnt vmcnt(9)
  v_fma_mix_f32 v152, v152, v24, v28 op_sel_hi:[1,0,0]
  v_fma_mix_f32 v153, v153, v25, v29 op_sel_hi:[1,0,0]
  v_fma_mix_f32 v154, v154, v26, v30 op_sel_hi:[1,0,0]
  v_fma_mix_f32 v155, v155, v27, v31 op_sel_hi:[1,0,0]
  s_waitcnt vmcnt(8)
  v_fma_mix_f32 v156, v156, v24, v28 op_sel_hi:[1,0,0]
  v_fma_mix_f32 v157, v157, v25, v29 op_sel_hi:[1,0,0]
  buffer_load_dwordx4 v[176:179], v2, s[24:27], s44 offen
  v_fma_mix_f32 v158, v158, v26, v30 op_sel_hi:[1,0,0]
  v_fma_mix_f32 v159, v159, v27, v31 op_sel_hi:[1,0,0]
  v_cvt_pk_bf16_f32 v51, v152, v156
  v_cvt_pk_bf16_f32 v55, v153, v157
  v_cvt_pk_bf16_f32 v59, v154, v158
  v_cvt_pk_bf16_f32 v63, v155, v159
  ds_read_b128 v[20:23], v5 offset:2048
  buffer_load_dwordx4 v[180:183], v2, s[24:27], s45 offen
  buffer_load_dwordx4 v[184:187], v2, s[24:27], s46 offen
  buffer_load_dwordx4 v[188:191], v2, s[24:27], s47 offen
  s_waitcnt lgkmcnt(1)
  s_barrier
  ds_write_b128 v7, v[48:51] offset:16384
  v_lshl_add_u32 v18, s71, 7, v19
  s_add_u32 m0, s8, 119808
  s_nop 0
  buffer_load_dwordx4 v18, s[20:23], 0 offen lds
L_w4a:
  s_cbranch_execz L_wret1a
  ds_write_b128 v7, v[52:55] offset:17408
  ds_write_b128 v7, v[56:59] offset:18432
  s_add_u32 m0, s8, 123904
  s_nop 0
  buffer_load_dwordx4 v18, s[20:23], s48 offen lds
  ds_write_b128 v7, v[60:63] offset:19456
  s_waitcnt lgkmcnt(4)
  v_mul_f32 v28, 0xb5000000, v20
  v_mul_f32 v29, 0xb5000000, v21
  v_mul_f32 v30, 0xb5000000, v22
  v_mul_f32 v31, 0xb5000000, v23
  s_waitcnt vmcnt(9)
  v_fma_mix_f32 v160, v160, v20, v28 op_sel_hi:[1,0,0]
  v_fma_mix_f32 v161, v161, v21, v29 op_sel_hi:[1,0,0]
  v_fma_mix_f32 v162, v162, v22, v30 op_sel_hi:[1,0,0]
  s_add_u32 m0, s8, 128000
  s_nop 0
  buffer_load_dwordx4 v18, s[20:23], s49 offen lds
  v_fma_mix_f32 v163, v163, v23, v31 op_sel_hi:[1,0,0]
  s_waitcnt vmcnt(9)
  v_fma_mix_f32 v164, v164, v20, v28 op_sel_hi:[1,0,0]
  v_fma_mix_f32 v165, v165, v21, v29 op_sel_hi:[1,0,0]
  v_fma_mix_f32 v166, v166, v22, v30 op_sel_hi:[1,0,0]
  v_fma_mix_f32 v167, v167, v23, v31 op_sel_hi:[1,0,0]
  v_cvt_pk_bf16_f32 v32, v160, v164
  v_cvt_pk_bf16_f32 v36, v161, v165
  v_cvt_pk_bf16_f32 v40, v162, v166
  v_cvt_pk_bf16_f32 v44, v163, v167
  s_waitcnt vmcnt(8)
  v_fma_mix_f32 v168, v168, v20, v28 op_sel_hi:[1,0,0]
  v_fma_mix_f32 v169, v169, v21, v29 op_sel_hi:[1,0,0]
  v_fma_mix_f32 v170, v170, v22, v30 op_sel_hi:[1,0,0]
  s_add_u32 m0, s8, 132096
  s_nop 0
  buffer_load_dwordx4 v18, s[20:23], s50 offen lds
  v_fma_mix_f32 v171, v171, v23, v31 op_sel_hi:[1,0,0]
  s_waitcnt vmcnt(8)
  v_fma_mix_f32 v172, v172, v20, v28 op_sel_hi:[1,0,0]
  v_fma_mix_f32 v173, v173, v21, v29 op_sel_hi:[1,0,0]
  v_fma_mix_f32 v174, v174, v22, v30 op_sel_hi:[1,0,0]
  v_fma_mix_f32 v175, v175, v23, v31 op_sel_hi:[1,0,0]
  v_cvt_pk_bf16_f32 v33, v168, v172
  v_cvt_pk_bf16_f32 v37, v169, v173
  v_cvt_pk_bf16_f32 v41, v170, v174
  v_cvt_pk_bf16_f32 v45, v171, v175
  s_waitcnt vmcnt(7)
  v_fma_mix_f32 v176, v176, v20, v28 op_sel_hi:[1,0,0]
  v_fma_mix_f32 v177, v177, v21, v29 op_sel_hi:[1,0,0]
  v_fma_mix_f32 v178, v178, v22, v30 op_sel_hi:[1,0,0]
  v_fma_mix_f32 v179, v179, v23, v31 op_sel_hi:[1,0,0]
  s_add_u32 m0, s8, 58368
  s_nop 0
  buffer_load_dwordx4 v3, s[20:23], s51 offen lds
  s_waitcnt vmcnt(7)
  v_fma_mix_f32 v180, v180, v20, v28 op_sel_hi:[1,0,0]
  v_fma_mix_f32 v181, v181, v21, v29 op_sel_hi:[1,0,0]
  v_fma_mix_f32 v182, v182, v22, v30 op_sel_hi:[1,0,0]
  v_fma_mix_f32 v183, v183, v23, v31 op_sel_hi:[1,0,0]
  v_cvt_pk_bf16_f32 v34, v176, v180
  v_cvt_pk_bf16_f32 v38, v177, v181
  v_cvt_pk_bf16_f32 v42, v178, v182
  s_waitcnt lgkmcnt(0)
  s_barrier
  v_cvt_pk_bf16_f32 v46, v179, v183
  s_waitcnt vmcnt(6)
  v_fma_mix_f32 v184, v184, v20, v28 op_sel_hi:[1,0,0]
  v_fma_mix_f32 v185, v185, v21, v29 op_sel_hi:[1,0,0]
  v_fma_mix_f32 v186, v186, v22, v30 op_sel_hi:[1,0,0]
  v_fma_mix_f32 v187, v187, v23, v31 op_sel_hi:[1,0,0]
  s_add_u32 m0, s8, 62464
  s_nop 0
  buffer_load_dwordx4 v3, s[20:23], s52 offen lds
  s_waitcnt vmcnt(6)
  v_fma_mix_f32 v188, v188, v20, v28 op_sel_hi:[1,0,0]
  v_fma_mix_f32 v189, v189, v21, v29 op_sel_hi:[1,0,0]
  v_fma_mix_f32 v190, v190, v22, v30 op_sel_hi:[1,0,0]
  v_fma_mix_f32 v191, v191, v23, v31 op_sel_hi:[1,0,0]
  v_cvt_pk_bf16_f32 v35, v184, v188
  v_cvt_pk_bf16_f32 v39, v185, v189
  v_cvt_pk_bf16_f32 v43, v186, v190
  v_cvt_pk_bf16_f32 v47, v187, v191
  ds_write_b128 v7, v[32:35] offset:37888
  s_add_u32 m0, s8, 66560
  s_nop 0
  buffer_load_dwordx4 v3, s[20:23], s53 offen lds
  ds_write_b128 v7, v[36:39] offset:38912
  ds_write_b128 v7, v[40:43] offset:39936
  v_lshl_add_u32 v1, s69, 7, v1
  s_add_u32 m0, s9, 78848
  s_nop 0
  s_mov_b32 exec_hi, 0
  buffer_load_dwordx4 v1, s[20:23], 0 offen lds
  s_mov_b32 exec_hi, -1
  ds_write_b128 v7, v[44:47] offset:40960
  s_add_u32 m0, s8, 97280
  s_nop 0
  buffer_load_dwordx4 v19, s[20:23], s51 offen lds
  s_add_u32 m0, s8, 101376
  s_nop 0
  buffer_load_dwordx4 v19, s[20:23], s52 offen lds
  s_add_u32 m0, s8, 105472
  s_nop 0
  buffer_load_dwordx4 v19, s[20:23], s53 offen lds
  v_lshl_add_u32 v1, s70, 7, v1
  s_add_u32 m0, s9, 117760
  s_nop 0
  s_mov_b32 exec_hi, 0
  buffer_load_dwordx4 v1, s[20:23], 0 offen lds
  s_mov_b32 exec_hi, -1
  s_add_u32 m0, s8, 136192
  s_nop 0
  buffer_load_dwordx4 v18, s[20:23], s51 offen lds
  s_waitcnt vmcnt(9) lgkmcnt(0)
  s_barrier
  s_add_u32 m0, s8, 140288
  s_nop 0
  buffer_load_dwordx4 v18, s[20:23], s52 offen lds
  s_add_u32 m0, s8, 144384
  s_nop 0
  buffer_load_dwordx4 v18, s[20:23], s53 offen lds
  v_lshl_add_u32 v1, s71, 7, v1
  s_add_u32 m0, s9, 156672
  s_nop 0
  s_mov_b32 exec_hi, 0
  buffer_load_dwordx4 v1, s[20:23], 0 offen lds
  s_mov_b32 exec_hi, -1
  s_add_u32 m0, s8, 70656
  s_nop 0
  buffer_load_dwordx4 v3, s[20:23], s54 offen lds
  s_add_u32 m0, s8, 74752
  s_nop 0
  buffer_load_dwordx4 v3, s[20:23], s55 offen lds
  s_add_u32 m0, s8, 109568
  s_nop 0
  buffer_load_dwordx4 v19, s[20:23], s54 offen lds
  s_add_u32 m0, s8, 113664
  s_nop 0
  buffer_load_dwordx4 v19, s[20:23], s55 offen lds
  s_add_u32 m0, s8, 148480
  s_nop 0
  buffer_load_dwordx4 v18, s[20:23], s54 offen lds
  s_add_u32 m0, s8, 152576
  s_nop 0
  buffer_load_dwordx4 v18, s[20:23], s55 offen lds
  s_waitcnt vmcnt(14)
  s_barrier
  s_waitcnt vmcnt(10)
  s_barrier
  s_waitcnt vmcnt(6)
  s_barrier
  s_waitcnt vmcnt(0)
  s_barrier
  s_endpgm
L_endc0a:
L_beg0b:
  s_add_u32 m0, s8, 41984
  s_nop 0
  buffer_load_dwordx4 v3, s[20:23], 0 offen lds
  s_add_u32 m0, s8, 46080
  s_nop 0
  buffer_load_dwordx4 v3, s[20:23], s48 offen lds
  s_add_u32 m0, s8, 50176
  s_nop 0
  buffer_load_dwordx4 v3, s[20:23], s49 offen lds
  s_add_u32 m0, s8, 54272
  s_nop 0
  buffer_load_dwordx4 v3, s[20:23], s50 offen lds
  s_add_u32 m0, s8, 58368
  s_nop 0
  buffer_load_dwordx4 v3, s[20:23], s51 offen lds
  s_add_u32 m0, s8, 62464
  s_nop 0
  buffer_load_dwordx4 v3, s[20:23], s52 offen lds
  s_lshl_b32 s40, s35, 1
  v_xor_b32 v71, s40, v71
  v_lshl_add_u32 v71, v71, 4, v69
  s_mul_i32 s40, s3, 4608
  s_add_u32 s40, s40, s15
  s_add_u32 s40, s40, 331776
  v_add_u32 v76, s40, v71
  s_lshl_b32 s9, s3, 9
  s_mov_b32 s10, 0x4b800000
  s_mov_b32 s11, 0xffff0000
  s_mul_i32 s40, s3, 2304
  s_add_u32 s40, s40, 32768
  v_lshl_add_u32 v5, v64, 4, s40
  v_lshl_add_u32 v6, v65, 8, v5
  s_lshl_b32 s40, s3, 12
  v_lshl_add_u32 v7, v1, 4, s40
  v_mov_b32 v1, v76
  s_bfe_u32 s15, s32, 262148
  s_add_u32 s15, s15, s19
  s_sub_u32 s40, s15, 9
  s_min_u32 s15, s15, s40
  s_sub_u32 s64, s15, s19
  s_mul_i32 s56, s64, 9
  s_bfe_u32 s14, s32, 262152
  s_add_u32 s14, s14, s19
  s_sub_u32 s40, s14, 9
  s_min_u32 s14, s14, s40
  s_sub_u32 s65, s14, s15
  s_mul_i32 s57, s65, 9
  s_bfe_u32 s15, s32, 262156
  s_add_u32 s15, s15, s19
  s_sub_u32 s40, s15, 9
  s_min_u32 s15, s15, s40
  s_sub_u32 s66, s15, s14
  s_mul_i32 s58, s66, 9
  s_bfe_u32 s14, s32, 262160
  s_add_u32 s14, s14, s19
  s_sub_u32 s40, s14, 9
  s_min_u32 s14, s14, s40
  s_sub_u32 s67, s14, s15
  s_mul_i32 s59, s67, 9
  s_bfe_u32 s15, s32, 262164
  s_add_u32 s15, s15, s19
  s_sub_u32 s40, s15, 9
  s_min_u32 s15, s15, s40
  s_sub_u32 s68, s15, s14
  s_mul_i32 s60, s68, 9
  s_bfe_u32 s14, s32, 262168
  s_add_u32 s14, s14, s19
  s_sub_u32 s40, s14, 9
  s_min_u32 s14, s14, s40
  s_sub_u32 s69, s14, s15
  s_mul_i32 s61, s69, 9
  s_bfe_u32 s15, s32, 262172
  s_add_u32 s15, s15, s19
  s_sub_u32 s40, s15, 9
  s_min_u32 s15, s15, s40
  s_sub_u32 s70, s15, s14
  s_mul_i32 s62, s70, 9
  s_mov_b32 s14, s33
  s_add_u32 s14, s14, s19
  s_sub_u32 s40, s14, 9
  s_min_u32 s14, s14, s40
  s_sub_u32 s71, s14, s15
  s_mul_i32 s63, s71, 9
  s_add_u32 m0, s8, 66560
  s_nop 0
  buffer_load_dwordx4 v3, s[20:23], s53 offen lds
  s_add_u32 m0, s8, 70656
  s_nop 0
  buffer_load_dwordx4 v3, s[20:23], s54 offen lds
  s_add_u32 m0, s8, 74752
  s_nop 0
  buffer_load_dwordx4 v3, s[20:23], s55 offen lds
  s_waitcnt vmcnt(11)
  v_lshlrev_b32 v84, 16, v12
  v_and_b32 v85, s11, v12
  v_lshlrev_b32 v86, 16, v13
  v_and_b32 v87, s11, v13
  v_mul_f32 v84, s10, v84
  v_mul_f32 v85, s10, v85
  v_mul_f32 v86, s10, v86
  v_mul_f32 v87, s10, v87
  ds_write_b128 v6, v[84:87] offset:0
  ds_read_b128 v[20:23], v5 offset:0
  s_waitcnt vmcnt(10)
  v_lshlrev_b32 v88, 16, v14
  v_and_b32 v89, s11, v14
  v_lshlrev_b32 v90, 16, v15
  v_and_b32 v91, s11, v15
  v_mul_f32 v88, s10, v88
  v_mul_f32 v89, s10, v89
  v_mul_f32 v90, s10, v90
  v_mul_f32 v91, s10, v91
  ds_write_b128 v6, v[88:91] offset:1024
  s_waitcnt lgkmcnt(1)
  v_mul_f32 v28, 0xb5000000, v20
  v_mul_f32 v29, 0xb5000000, v21
  v_mul_f32 v30, 0xb5000000, v22
  v_mul_f32 v31, 0xb5000000, v23
  v_fma_mix_f32 v96, v96, v20, v28 op_sel_hi:[1,0,0]
  v_fma_mix_f32 v97, v97, v21, v29 op_sel_hi:[1,0,0]
  v_fma_mix_f32 v98, v98, v22, v30 op_sel_hi:[1,0,0]
  v_fma_mix_f32 v99, v99, v23, v31 op_sel_hi:[1,0,0]
  v_fma_mix_f32 v100, v100, v20, v28 op_sel_hi:[1,0,0]
  v_lshl_add_u32 v2, s56, 17, v2
  buffer_load_dwordx4 v[128:131], v2, s[24:27], 0 offen
  v_fma_mix_f32 v101, v101, v21, v29 op_sel_hi:[1,0,0]
  v_fma_mix_f32 v102, v102, v22, v30 op_sel_hi:[1,0,0]
  v_fma_mix_f32 v103, v103, v23, v31 op_sel_hi:[1,0,0]
  v_cvt_pk_bf16_f32 v32, v96, v100
  v_cvt_pk_bf16_f32 v36, v97, v101
  buffer_load_dwordx4 v[132:135], v2, s[24:27], s41 offen
  v_cvt_pk_bf16_f32 v40, v98, v102
  v_cvt_pk_bf16_f32 v44, v99, v103
  v_fma_mix_f32 v104, v104, v20, v28 op_sel_hi:[1,0,0]
  v_fma_mix_f32 v105, v105, v21, v29 op_sel_hi:[1,0,0]
  v_fma_mix_f32 v106, v106, v22, v30 op_sel_hi:[1,0,0]
  buffer_load_dwordx4 v[136:139], v2, s[24:27], s42 offen
  v_fma_mix_f32 v107, v107, v23, v31 op_sel_hi:[1,0,0]
  v_fma_mix_f32 v108, v108, v20, v28 op_sel_hi:[1,0,0]
  v_fma_mix_f32 v109, v109, v21, v29 op_sel_hi:[1,0,0]
  v_fma_mix_f32 v110, v110, v22, v30 op_sel_hi:[1,0,0]
  v_fma_mix_f32 v111, v111, v23, v31 op_sel_hi:[1,0,0]
  buffer_load_dwordx4 v[140:143], v2, s[24:27], s43 offen
  v_cvt_pk_bf16_f32 v33, v104, v108
  v_cvt_pk_bf16_f32 v37, v105, v109
  v_cvt_pk_bf16_f32 v41, v106, v110
  v_cvt_pk_bf16_f32 v45, v107, v111
  v_fma_mix_f32 v112, v112, v20, v28 op_sel_hi:[1,0,0]
  buffer_load_dwordx4 v[144:147], v2, s[24:27], s44 offen
  v_fma_mix_f32 v113, v113, v21, v29 op_sel_hi:[1,0,0]
  v_fma_mix_f32 v114, v114, v22, v30 op_sel_hi:[1,0,0]
  v_fma_mix_f32 v115, v115, v23, v31 op_sel_hi:[1,0,0]
  v_fma_mix_f32 v116, v116, v20, v28 op_sel_hi:[1,0,0]
  v_fma_mix_f32 v117, v117, v21, v29 op_sel_hi:[1,0,0]
  buffer_load_dwordx4 v[148:151], v2, s[24:27], s45 offen
  v_fma_mix_f32 v118, v118, v22, v30 op_sel_hi:[1,0,0]
  v_fma_mix_f32 v119, v119, v23, v31 op_sel_hi:[1,0,0]
  v_cvt_pk_bf16_f32 v34, v112, v116
  v_cvt_pk_bf16_f32 v38, v113, v117
  v_cvt_pk_bf16_f32 v42, v114, v118
  buffer_load_dwordx4 v[152:155], v2, s[24:27], s46 offen
  v_cvt_pk_bf16_f32 v46, v115, v119
  v_fma_mix_f32 v120, v120, v20, v28 op_sel_hi:[1,0,0]
  v_fma_mix_f32 v121, v121, v21, v29 op_sel_hi:[1,0,0]
  v_fma_mix_f32 v122, v122, v22, v30 op_sel_hi:[1,0,0]
  v_fma_mix_f32 v123, v123, v23, v31 op_sel_hi:[1,0,0]
  buffer_load_dwordx4 v[156:159], v2, s[24:27], s47 offen
  v_fma_mix_f32 v124, v124, v20, v28 op_sel_hi:[1,0,0]
  v_fma_mix_f32 v125, v125, v21, v29 op_sel_hi:[1,0,0]
  v_fma_mix_f32 v126, v126, v22, v30 op_sel_hi:[1,0,0]
  v_fma_mix_f32 v127, v127, v23, v31 op_sel_hi:[1,0,0]
  v_cvt_pk_bf16_f32 v35, v120, v124
  v_lshl_add_u32 v3, s64, 7, v3
  s_add_u32 m0, s8, 80896
  s_nop 0
  buffer_load_dwordx4 v3, s[20:23], 0 offen lds
  v_cvt_pk_bf16_f32 v39, v121, v125
  v_cvt_pk_bf16_f32 v43, v122, v126
  v_cvt_pk_bf16_f32 v47, v123, v127
  s_waitcnt vmcnt(18)
  v_lshlrev_b32 v92, 16, v16
  v_and_b32 v93, s11, v16
  v_lshlrev_b32 v94, 16, v17
  v_and_b32 v95, s11, v17
  v_mul_f32 v92, s10, v92
  v_mul_f32 v93, s10, v93
  v_mul_f32 v94, s10, v94
  v_mul_f32 v95, s10, v95
  s_mov_b64 exec, 0xffff
  ds_write_b128 v6, v[92:95] offset:2048
  s_mov_b64 exec, -1
  ds_read_b128 v[24:27], v5 offset:256
  ds_write_b128 v7, v[32:35] offset:0
  ds_write_b128 v7, v[36:39] offset:1024
  ds_write_b128 v7, v[40:43] offset:2048
  ds_write_b128 v7, v[44:47] offset:3072
  s_add_u32 m0, s8, 84992
  s_nop 0
  buffer_load_dwordx4 v3, s[20:23], s48 offen lds
  s_waitcnt lgkmcnt(4)
  v_mul_f32 v28, 0xb5000000, v24
  s_waitcnt vmcnt(10) lgkmcnt(0)
  s_barrier
  v_mul_f32 v29, 0xb5000000, v25
  v_mul_f32 v30, 0xb5000000, v26
  s_add_u32 m0, s8, 89088
  s_nop 0
  buffer_load_dwordx4 v3, s[20:23], s49 offen lds
  v_mul_f32 v31, 0xb5000000, v27
  s_waitcnt vmcnt(10)
  v_fma_mix_f32 v128, v128, v24, v28 op_sel_hi:[1,0,0]
  v_fma_mix_f32 v129, v129, v25, v29 op_sel_hi:[1,0,0]
  v_fma_mix_f32 v130, v130, v26, v30 op_sel_hi:[1,0,0]
  v_fma_mix_f32 v131, v131, v27, v31 op_sel_hi:[1,0,0]
  s_add_u32 m0, s8, 93184
  s_nop 0
  buffer_load_dwordx4 v3, s[20:23], s50 offen lds
  s_waitcnt vmcnt(10)
  v_fma_mix_f32 v132, v132, v24, v28 op_sel_hi:[1,0,0]
  v_fma_mix_f32 v133, v133, v25, v29 op_sel_hi:[1,0,0]
  v_fma_mix_f32 v134, v134, v26, v30 op_sel_hi:[1,0,0]
  v_fma_mix_f32 v135, v135, v27, v31 op_sel_hi:[1,0,0]
  v_cvt_pk_bf16_f32 v48, v128, v132
  s_add_u32 m0, s8, 97280
  s_nop 0
  buffer_load_dwordx4 v3, s[20:23], s51 offen lds
  v_cvt_pk_bf16_f32 v52, v129, v133
  v_cvt_pk_bf16_f32 v56, v130, v134
  v_cvt_pk_bf16_f32 v60, v131, v135
  s_waitcnt vmcnt(10)
  v_fma_mix_f32 v136, v136, v24, v28 op_sel_hi:[1,0,0]
  v_fma_mix_f32 v137, v137, v25, v29 op_sel_hi:[1,0,0]
  s_add_u32 m0, s8, 101376
  s_nop 0
  buffer_load_dwordx4 v3, s[20:23], s52 offen lds
  v_fma_mix_f32 v138, v138, v26, v30 op_sel_hi:[1,0,0]
  v_fma_mix_f32 v139, v139, v27, v31 op_sel_hi:[1,0,0]
  s_waitcnt vmcnt(10)
  v_fma_mix_f32 v140, v140, v24, v28 op_sel_hi:[1,0,0]
  v_fma_mix_f32 v141, v141, v25, v29 op_sel_hi:[1,0,0]
  v_fma_mix_f32 v142, v142, v26, v30 op_sel_hi:[1,0,0]
  s_add_u32 m0, s8, 105472
  s_nop 0
  buffer_load_dwordx4 v3, s[20:23], s53 offen lds
  v_fma_mix_f32 v143, v143, v27, v31 op_sel_hi:[1,0,0]
  v_cvt_pk_bf16_f32 v49, v136, v140
  v_cvt_pk_bf16_f32 v53, v137, v141
  v_cvt_pk_bf16_f32 v57, v138, v142
  v_cvt_pk_bf16_f32 v61, v139, v143
  s_add_u32 m0, s8, 109568
  s_nop 0
  buffer_load_dwordx4 v3, s[20:23], s54 offen lds
  s_waitcnt vmcnt(11)
  v_fma_mix_f32 v144, v144, v24, v28 op_sel_hi:[1,0,0]
  v_fma_mix_f32 v145, v145, v25, v29 op_sel_hi:[1,0,0]
  v_fma_mix_f32 v146, v146, v26, v30 op_sel_hi:[1,0,0]
  v_fma_mix_f32 v147, v147, v27, v31 op_sel_hi:[1,0,0]
  s_waitcnt vmcnt(10)
  v_fma_mix_f32 v148, v148, v24, v28 op_sel_hi:[1,0,0]
  s_add_u32 m0, s8, 113664
  s_nop 0
  buffer_load_dwordx4 v3, s[20:23], s55 offen lds
  v_fma_mix_f32 v149, v149, v25, v29 op_sel_hi:[1,0,0]
  v_fma_mix_f32 v150, v150, v26, v30 op_sel_hi:[1,0,0]
  v_fma_mix_f32 v151, v151, v27, v31 op_sel_hi:[1,0,0]
  v_cvt_pk_bf16_f32 v50, v144, v148
  v_cvt_pk_bf16_f32 v54, v145, v149
  v_lshl_add_u32 v2, s57, 17, v2
  buffer_load_dwordx4 v[160:163], v2, s[24:27], 0 offen
  v_cvt_pk_bf16_f32 v58, v146, v150
  v_cvt_pk_bf16_f32 v62, v147, v151
  s_waitcnt vmcnt(11)
  v_fma_mix_f32 v152, v152, v24, v28 op_sel_hi:[1,0,0]
  v_fma_mix_f32 v153, v153, v25, v29 op_sel_hi:[1,0,0]
  v_fma_mix_f32 v154, v154, v26, v30 op_sel_hi:[1,0,0]
  buffer_load_dwordx4 v[164:167], v2, s[24:27], s41 offen
  v_fma_mix_f32 v155, v155, v27, v31 op_sel_hi:[1,0,0]
  s_waitcnt vmcnt(11)
  v_fma_mix_f32 v156, v156, v24, v28 op_sel_hi:[1,0,0]
  v_fma_mix_f32 v157, v157, v25, v29 op_sel_hi:[1,0,0]
  v_fma_mix_f32 v158, v158, v26, v30 op_sel_hi:[1,0,0]
  v_fma_mix_f32 v159, v159, v27, v31 op_sel_hi:[1,0,0]
  buffer_load_dwordx4 v[168:171], v2, s[24:27], s42 offen
  v_cvt_pk_bf16_f32 v51, v152, v156
  v_cvt_pk_bf16_f32 v55, v153, v157
  v_cvt_pk_bf16_f32 v59, v154, v158
  v_cvt_pk_bf16_f32 v63, v155, v159
  ds_read_b128 v[20:23], v5 offset:512
  ds_write_b128 v7, v[48:51] offset:16384
  buffer_load_dwordx4 v[172:175], v2, s[24:27], s43 offen
  ds_write_b128 v7, v[52:55] offset:17408
  buffer_load_dwordx4 v[176:179], v2, s[24:27], s44 offen
  ds_write_b128 v7, v[56:59] offset:18432
  buffer_load_dwordx4 v[180:183], v2, s[24:27], s45 offen
  ds_write_b128 v7, v[60:63] offset:19456
  buffer_load_dwordx4 v[184:187], v2, s[24:27], s46 offen
  buffer_load_dwordx4 v[188:191], v2, s[24:27], s47 offen
  v_lshl_add_u32 v3, s65, 7, v3
  s_add_u32 m0, s8, 119808
  s_nop 0
  buffer_load_dwordx4 v3, s[20:23], 0 offen lds
  s_add_u32 m0, s8, 123904
  s_nop 0
  buffer_load_dwordx4 v3, s[20:23], s48 offen lds
  s_waitcnt lgkmcnt(4)
  v_mul_f32 v28, 0xb5000000, v20
  s_waitcnt vmcnt(10) lgkmcnt(0)
  s_barrier
  v_mul_f32 v29, 0xb5000000, v21
  v_mul_f32 v30, 0xb5000000, v22
  s_add_u32 m0, s8, 128000
  s_nop 0
  buffer_load_dwordx4 v3, s[20:23], s49 offen lds
  v_mul_f32 v31, 0xb5000000, v23
  s_waitcnt vmcnt(10)
  v_fma_mix_f32 v160, v160, v20, v28 op_sel_hi:[1,0,0]
  v_fma_mix_f32 v161, v161, v21, v29 op_sel_hi:[1,0,0]
  v_fma_mix_f32 v162, v162, v22, v30 op_sel_hi:[1,0,0]
  v_fma_mix_f32 v163, v163, v23, v31 op_sel_hi:[1,0,0]
  s_add_u32 m0, s8, 132096
  s_nop 0
  buffer_load_dwordx4 v3, s[20:23], s50 offen lds
  s_waitcnt vmcnt(10)
  v_fma_mix_f32 v164, v164, v20, v28 op_sel_hi:[1,0,0]
  v_fma_mix_f32 v165, v165, v21, v29 op_sel_hi:[1,0,0]
  v_fma_mix_f32 v166, v166, v22, v30 op_sel_hi:[1,0,0]
  v_fma_mix_f32 v167, v167, v23, v31 op_sel_hi:[1,0,0]
  v_cvt_pk_bf16_f32 v32, v160, v164
  s_add_u32 m0, s8, 136192
  s_nop 0
  buffer_load_dwordx4 v3, s[20:23], s51 offen lds
  v_cvt_pk_bf16_f32 v36, v161, v165
  v_cvt_pk_bf16_f32 v40, v162, v166
  v_cvt_pk_bf16_f32 v44, v163, v167
  s_waitcnt vmcnt(10)
  v_fma_mix_f32 v168, v168, v20, v28 op_sel_hi:[1,0,0]
  v_fma_mix_f32 v169, v169, v21, v29 op_sel_hi:[1,0,0]
  s_add_u32 m0, s8, 140288
  s_nop 0
  buffer_load_dwordx4 v3, s[20:23], s52 offen lds
  v_fma_mix_f32 v170, v170, v22, v30 op_sel_hi:[1,0,0]
  v_fma_mix_f32 v171, v171, v23, v31 op_sel_hi:[1,0,0]
  s_waitcnt vmcnt(10)
  v_fma_mix_f32 v172, v172, v20, v28 op_sel_hi:[1,0,0]
  v_fma_mix_f32 v173, v173, v21, v29 op_sel_hi:[1,0,0]
  v_fma_mix_f32 v174, v174, v22, v30 op_sel_hi:[1,0,0]
  s_add_u32 m0, s8, 144384
  s_nop 0
  buffer_load_dwordx4 v3, s[20:23], s53 offen lds
  v_fma_mix_f32 v175, v175, v23, v31 op_sel_hi:[1,0,0]
  v_cvt_pk_bf16_f32 v33, v168, v172
  v_cvt_pk_bf16_f32 v37, v169, v173
  v_cvt_pk_bf16_f32 v41, v170, v174
  v_cvt_pk_bf16_f32 v45, v171, v175
  s_add_u32 m0, s8, 148480
  s_nop 0
  buffer_load_dwordx4 v3, s[20:23], s54 offen lds
  s_waitcnt vmcnt(11)
  v_fma_mix_f32 v176, v176, v20, v28 op_sel_hi:[1,0,0]
  v_fma_mix_f32 v177, v177, v21, v29 op_sel_hi:[1,0,0]
  v_fma_mix_f32 v178, v178, v22, v30 op_sel_hi:[1,0,0]
  v_fma_mix_f32 v179, v179, v23, v31 op_sel_hi:[1,0,0]
  s_waitcnt vmcnt(10)
  v_fma_mix_f32 v180, v180, v20, v28 op_sel_hi:[1,0,0]
  s_add_u32 m0, s8, 152576
  s_nop 0
  buffer_load_dwordx4 v3, s[20:23], s55 offen lds
  v_fma_mix_f32 v181, v181, v21, v29 op_sel_hi:[1,0,0]
  v_fma_mix_f32 v182, v182, v22, v30 op_sel_hi:[1,0,0]
  v_fma_mix_f32 v183, v183, v23, v31 op_sel_hi:[1,0,0]
  v_cvt_pk_bf16_f32 v34, v176, v180
  v_cvt_pk_bf16_f32 v38, v177, v181
  v_lshl_add_u32 v2, s58, 17, v2
  buffer_load_dwordx4 v[96:99], v2, s[24:27], 0 offen
  v_cvt_pk_bf16_f32 v42, v178, v182
  v_cvt_pk_bf16_f32 v46, v179, v183
  s_waitcnt vmcnt(11)
  v_fma_mix_f32 v184, v184, v20, v28 op_sel_hi:[1,0,0]
  v_fma_mix_f32 v185, v185, v21, v29 op_sel_hi:[1,0,0]
  v_fma_mix_f32 v186, v186, v22, v30 op_sel_hi:[1,0,0]
  buffer_load_dwordx4 v[100:103], v2, s[24:27], s41 offen
  v_fma_mix_f32 v187, v187, v23, v31 op_sel_hi:[1,0,0]
  s_waitcnt vmcnt(11)
  v_fma_mix_f32 v188, v188, v20, v28 op_sel_hi:[1,0,0]
  v_fma_mix_f32 v189, v189, v21, v29 op_sel_hi:[1,0,0]
  v_fma_mix_f32 v190, v190, v22, v30 op_sel_hi:[1,0,0]
  v_fma_mix_f32 v191, v191, v23, v31 op_sel_hi:[1,0,0]
  buffer_load_dwordx4 v[104:107], v2, s[24:27], s42 offen
  v_cvt_pk_bf16_f32 v35, v184, v188
  v_cvt_pk_bf16_f32 v39, v185, v189
  v_cvt_pk_bf16_f32 v43, v186, v190
  v_cvt_pk_bf16_f32 v47, v187, v191
  ds_read_b128 v[24:27], v5 offset:768
  ds_write_b128 v7, v[32:35] offset:0
  buffer_load_dwordx4 v[108:111], v2, s[24:27], s43 offen
  ds_write_b128 v7, v[36:39] offset:1024
  buffer_load_dwordx4 v[112:115], v2, s[24:27], s44 offen
  ds_write_b128 v7, v[40:43] offset:2048
  buffer_load_dwordx4 v[116:119], v2, s[24:27], s45 offen
  ds_write_b128 v7, v[44:47] offset:3072
  buffer_load_dwordx4 v[120:123], v2, s[24:27], s46 offen
  buffer_load_dwordx4 v[124:127], v2, s[24:27], s47 offen
  v_lshl_add_u32 v3, s66, 7, v3
  s_add_u32 m0, s8, 41984
  s_nop 0
  buffer_load_dwordx4 v3, s[20:23], 0 offen lds
  s_add_u32 m0, s8, 46080
  s_nop 0
  buffer_load_dwordx4 v3, s[20:23], s48 offen lds
  s_add_u32 m0, s8, 50176
  s_nop 0
  buffer_load_dwordx4 v3, s[20:23], s49 offen lds
  s_add_u32 m0, s8, 54272
  s_nop 0
  buffer_load_dwordx4 v3, s[20:23], s50 offen lds
  s_add_u32 m0, s8, 58368
  s_nop 0
  buffer_load_dwordx4 v3, s[20:23], s51 offen lds
  s_add_u32 m0, s8, 62464
  s_nop 0
  buffer_load_dwordx4 v3, s[20:23], s52 offen lds
  s_waitcnt lgkmcnt(4)
  v_mul_f32 v28, 0xb5000000, v24
  s_waitcnt vmcnt(14) lgkmcnt(0)
  s_barrier
  v_mul_f32 v29, 0xb5000000, v25
  v_mul_f32 v30, 0xb5000000, v26
  s_add_u32 m0, s8, 66560
  s_nop 0
  buffer_load_dwordx4 v3, s[20:23], s53 offen lds
  v_mul_f32 v31, 0xb5000000, v27
  s_waitcnt vmcnt(14)
  v_fma_mix_f32 v96, v96, v24, v28 op_sel_hi:[1,0,0]
  v_fma_mix_f32 v97, v97, v25, v29 op_sel_hi:[1,0,0]
  v_fma_mix_f32 v98, v98, v26, v30 op_sel_hi:[1,0,0]
  v_fma_mix_f32 v99, v99, v27, v31 op_sel_hi:[1,0,0]
  s_add_u32 m0, s8, 70656
  s_nop 0
  buffer_load_dwordx4 v3, s[20:23], s54 offen lds
  s_waitcnt vmcnt(14)
  v_fma_mix_f32 v100, v100, v24, v28 op_sel_hi:[1,0,0]
  v_fma_mix_f32 v101, v101, v25, v29 op_sel_hi:[1,0,0]
  v_fma_mix_f32 v102, v102, v26, v30 op_sel_hi:[1,0,0]
  v_fma_mix_f32 v103, v103, v27, v31 op_sel_hi:[1,0,0]
  v_cvt_pk_bf16_f32 v48, v96, v100
  s_add_u32 m0, s8, 74752
  s_nop 0
  buffer_load_dwordx4 v3, s[20:23], s55 offen lds
  v_cvt_pk_bf16_f32 v52, v97, v101
  v_cvt_pk_bf16_f32 v56, v98, v102
  v_cvt_pk_bf16_f32 v60, v99, v103
  s_waitcnt vmcnt(14)
  v_fma_mix_f32 v104, v104, v24, v28 op_sel_hi:[1,0,0]
L_w3b:
  s_cbranch_execz L_wret1b
  v_fma_mix_f32 v105, v105, v25, v29 op_sel_hi:[1,0,0]
  v_lshl_add_u32 v2, s59, 17, v2
  buffer_load_dwordx4 v[128:131], v2, s[24:27], 0 offen
  v_fma_mix_f32 v106, v106, v26, v30 op_sel_hi:[1,0,0]
  v_fma_mix_f32 v107, v107, v27, v31 op_sel_hi:[1,0,0]
  s_waitcnt vmcnt(14)
  v_fma_mix_f32 v108, v108, v24, v28 op_sel_hi:[1,0,0]
  v_fma_mix_f32 v109, v109, v25, v29 op_sel_hi:[1,0,0]
  v_fma_mix_f32 v110, v110, v26, v30 op_sel_hi:[1,0,0]
  buffer_load_dwordx4 v[132:135], v2, s[24:27], s41 offen
  v_fma_mix_f32 v111, v111, v27, v31 op_sel_hi:[1,0,0]
  v_cvt_pk_bf16_f32 v49, v104, v108
  v_cvt_pk_bf16_f32 v53, v105, v109
  v_cvt_pk_bf16_f32 v57, v106, v110
  v_cvt_pk_bf16_f32 v61, v107, v111
  buffer_load_dwordx4 v[136:139], v2, s[24:27], s42 offen
  s_waitcnt vmcnt(15)
  v_fma_mix_f32 v112, v112, v24, v28 op_sel_hi:[1,0,0]
  v_fma_mix_f32 v113, v113, v25, v29 op_sel_hi:[1,0,0]
  v_fma_mix_f32 v114, v114, v26, v30 op_sel_hi:[1,0,0]
  v_fma_mix_f32 v115, v115, v27, v31 op_sel_hi:[1,0,0]
  s_waitcnt vmcnt(14)
  v_fma_mix_f32 v116, v116, v24, v28 op_sel_hi:[1,0,0]
  buffer_load_dwordx4 v[140:143], v2, s[24:27], s43 offen
  v_fma_mix_f32 v117, v117, v25, v29 op_sel_hi:[1,0,0]
  v_fma_mix_f32 v118, v118, v26, v30 op_sel_hi:[1,0,0]
  v_fma_mix_f32 v119, v119, v27, v31 op_sel_hi:[1,0,0]
  v_cvt_pk_bf16_f32 v50, v112, v116
  v_cvt_pk_bf16_f32 v54, v113, v117
  buffer_load_dwordx4 v[144:147], v2, s[24:27], s44 offen
  v_cvt_pk_bf16_f32 v58, v114, v118
  v_cvt_pk_bf16_f32 v62, v115, v119
  s_waitcnt vmcnt(15)
  v_fma_mix_f32 v120, v120, v24, v28 op_sel_hi:[1,0,0]
  v_fma_mix_f32 v121, v121, v25, v29 op_sel_hi:[1,0,0]
  v_fma_mix_f32 v122, v122, v26, v30 op_sel_hi:[1,0,0]
  buffer_load_dwordx4 v[148:151], v2, s[24:27], s45 offen
  v_fma_mix_f32 v123, v123, v27, v31 op_sel_hi:[1,0,0]
  s_waitcnt vmcnt(15)
  v_fma_mix_f32 v124, v124, v24, v28 op_sel_hi:[1,0,0]
  v_fma_mix_f32 v125, v125, v25, v29 op_sel_hi:[1,0,0]
  v_fma_mix_f32 v126, v126, v26, v30 op_sel_hi:[1,0,0]
  v_fma_mix_f32 v127, v127, v27, v31 op_sel_hi:[1,0,0]
  buffer_load_dwordx4 v[152:155], v2, s[24:27], s46 offen
  v_cvt_pk_bf16_f32 v51, v120, v124
  v_cvt_pk_bf16_f32 v55, v121, v125
  v_cvt_pk_bf16_f32 v59, v122, v126
  v_cvt_pk_bf16_f32 v63, v123, v127
  ds_read_b128 v[20:23], v5 offset:1024
  ds_write_b128 v7, v[48:51] offset:16384
  buffer_load_dwordx4 v[156:159], v2, s[24:27], s47 offen
  ds_write_b128 v7, v[52:55] offset:17408
  v_lshl_add_u32 v3, s67, 7, v3
  s_add_u32 m0, s8, 80896
  s_nop 0
  buffer_load_dwordx4 v3, s[20:23], 0 offen lds
  ds_write_b128 v7, v[56:59] offset:18432
  s_add_u32 m0, s8, 84992
  s_nop 0
  buffer_load_dwordx4 v3, s[20:23], s48 offen lds
  ds_write_b128 v7, v[60:63] offset:19456
  s_add_u32 m0, s8, 89088
  s_nop 0
  buffer_load_dwordx4 v3, s[20:23], s49 offen lds
  s_add_u32 m0, s8, 93184
  s_nop 0
  buffer_load_dwordx4 v3, s[20:23], s50 offen lds
  s_add_u32 m0, s8, 97280
  s_nop 0
  buffer_load_dwordx4 v3, s[20:23], s51 offen lds
  s_add_u32 m0, s8, 101376
  s_nop 0
  buffer_load_dwordx4 v3, s[20:23], s52 offen lds
  s_add_u32 m0, s8, 105472
  s_nop 0
  buffer_load_dwordx4 v3, s[20:23], s53 offen lds
  s_waitcnt lgkmcnt(4)
  v_mul_f32 v28, 0xb5000000, v20
  v_mul_f32 v29, 0xb5000000, v21
  v_mul_f32 v30, 0xb5000000, v22
  s_add_u32 m0, s8, 109568
  s_nop 0
  buffer_load_dwordx4 v3, s[20:23], s54 offen lds
  v_mul_f32 v31, 0xb5000000, v23
  s_waitcnt vmcnt(15)
  v_fma_mix_f32 v128, v128, v20, v28 op_sel_hi:[1,0,0]
  v_fma_mix_f32 v129, v129, v21, v29 op_sel_hi:[1,0,0]
  s_waitcnt lgkmcnt(0)
  s_barrier
  v_fma_mix_f32 v130, v130, v22, v30 op_sel_hi:[1,0,0]
  v_fma_mix_f32 v131, v131, v23, v31 op_sel_hi:[1,0,0]
  s_add_u32 m0, s8, 113664
  s_nop 0
  buffer_load_dwordx4 v3, s[20:23], s55 offen lds
  s_waitcnt vmcnt(15)
  v_fma_mix_f32 v132, v132, v20, v28 op_sel_hi:[1,0,0]
  v_fma_mix_f32 v133, v133, v21, v29 op_sel_hi:[1,0,0]
  v_fma_mix_f32 v134, v134, v22, v30 op_sel_hi:[1,0,0]
  v_fma_mix_f32 v135, v135, v23, v31 op_sel_hi:[1,0,0]
  v_cvt_pk_bf16_f32 v32, v128, v132
  v_lshl_add_u32 v2, s60, 17, v2
  buffer_load_dwordx4 v[160:163], v2, s[24:27], 0 offen
  v_cvt_pk_bf16_f32 v36, v129, v133
  v_cvt_pk_bf16_f32 v40, v130, v134
  v_cvt_pk_bf16_f32 v44, v131, v135
  s_waitcnt vmcnt(15)
  v_fma_mix_f32 v136, v136, v20, v28 op_sel_hi:[1,0,0]
  v_fma_mix_f32 v137, v137, v21, v29 op_sel_hi:[1,0,0]
  buffer_load_dwordx4 v[164:167], v2, s[24:27], s41 offen
  v_fma_mix_f32 v138, v138, v22, v30 op_sel_hi:[1,0,0]
  v_fma_mix_f32 v139, v139, v23, v31 op_sel_hi:[1,0,0]
  s_waitcnt vmcnt(15)
  v_fma_mix_f32 v140, v140, v20, v28 op_sel_hi:[1,0,0]
  v_fma_mix_f32 v141, v141, v21, v29 op_sel_hi:[1,0,0]
  v_fma_mix_f32 v142, v142, v22, v30 op_sel_hi:[1,0,0]
  buffer_load_dwordx4 v[168:171], v2, s[24:27], s42 offen
  v_fma_mix_f32 v143, v143, v23, v31 op_sel_hi:[1,0,0]
  v_cvt_pk_bf16_f32 v33, v136, v140
  v_cvt_pk_bf16_f32 v37, v137, v141
  v_cvt_pk_bf16_f32 v41, v138, v142
  v_cvt_pk_bf16_f32 v45, v139, v143
  buffer_load_dwordx4 v[172:175], v2, s[24:27], s43 offen
  s_waitcnt vmcnt(16)
  v_fma_mix_f32 v144, v144, v20, v28 op_sel_hi:[1,0,0]
  v_fma_mix_f32 v145, v145, v21, v29 op_sel_hi:[1,0,0]
  v_fma_mix_f32 v146, v146, v22, v30 op_sel_hi:[1,0,0]
  v_fma_mix_f32 v147, v147, v23, v31 op_sel_hi:[1,0,0]
  s_waitcnt vmcnt(15)
  v_fma_mix_f32 v148, v148, v20, v28 op_sel_hi:[1,0,0]
  buffer_load_dwordx4 v[176:179], v2, s[24:27], s44 offen
  v_fma_mix_f32 v149, v149, v21, v29 op_sel_hi:[1,0,0]
  v_fma_mix_f32 v150, v150, v22, v30 op_sel_hi:[1,0,0]
  v_fma_mix_f32 v151, v151, v23, v31 op_sel_hi:[1,0,0]
  v_cvt_pk_bf16_f32 v34, v144, v148
  v_cvt_pk_bf16_f32 v38, v145, v149
  buffer_load_dwordx4 v[180:183], v2, s[24:27], s45 offen
  v_cvt_pk_bf16_f32 v42, v146, v150
  v_cvt_pk_bf16_f32 v46, v147, v151
  s_waitcnt vmcnt(16)
  v_fma_mix_f32 v152, v152, v20, v28 op_sel_hi:[1,0,0]
  v_fma_mix_f32 v153, v153, v21, v29 op_sel_hi:[1,0,0]
  v_fma_mix_f32 v154, v154, v22, v30 op_sel_hi:[1,0,0]
  buffer_load_dwordx4 v[184:187], v2, s[24:27], s46 offen
  v_fma_mix_f32 v155, v155, v23, v31 op_sel_hi:[1,0,0]
  s_waitcnt vmcnt(16)
  v_fma_mix_f32 v156, v156, v20, v28 op_sel_hi:[1,0,0]
  v_fma_mix_f32 v157, v157, v21, v29 op_sel_hi:[1,0,0]
  v_fma_mix_f32 v158, v158, v22, v30 op_sel_hi:[1,0,0]
  v_fma_mix_f32 v159, v159, v23, v31 op_sel_hi:[1,0,0]
  buffer_load_dwordx4 v[188:191], v2, s[24:27], s47 offen
  v_cvt_pk_bf16_f32 v35, v152, v156
  v_cvt_pk_bf16_f32 v39, v153, v157
  v_cvt_pk_bf16_f32 v43, v154, v158
  v_cvt_pk_bf16_f32 v47, v155, v159
  ds_read_b128 v[24:27], v5 offset:1280
  ds_write_b128 v7, v[32:35] offset:0
  v_lshl_add_u32 v3, s68, 7, v3
  s_add_u32 m0, s8, 119808
  s_nop 0
  buffer_load_dwordx4 v3, s[20:23], 0 offen lds
  ds_write_b128 v7, v[36:39] offset:1024
  s_add_u32 m0, s8, 123904
  s_nop 0
  buffer_load_dwordx4 v3, s[20:23], s48 offen lds
  ds_write_b128 v7, v[40:43] offset:2048
  s_add_u32 m0, s8, 128000
  s_nop 0
  buffer_load_dwordx4 v3, s[20:23], s49 offen lds
  ds_write_b128 v7, v[44:47] offset:3072
  s_add_u32 m0, s8, 132096
  s_nop 0
  buffer_load_dwordx4 v3, s[20:23], s50 offen lds
  s_add_u32 m0, s8, 136192
  s_nop 0
  buffer_load_dwordx4 v3, s[20:23], s51 offen lds
  s_add_u32 m0, s8, 140288
  s_nop 0
  buffer_load_dwordx4 v3, s[20:23], s52 offen lds
  s_add_u32 m0, s8, 144384
  s_nop 0
  buffer_load_dwordx4 v3, s[20:23], s53 offen lds
  s_waitcnt lgkmcnt(4)
  v_mul_f32 v28, 0xb5000000, v24
  v_mul_f32 v29, 0xb5000000, v25
  v_mul_f32 v30, 0xb5000000, v26
  s_add_u32 m0, s8, 148480
  s_nop 0
  buffer_load_dwordx4 v3, s[20:23], s54 offen lds
  v_mul_f32 v31, 0xb5000000, v27
  s_waitcnt vmcnt(15)
  v_fma_mix_f32 v160, v160, v24, v28 op_sel_hi:[1,0,0]
  v_fma_mix_f32 v161, v161, v25, v29 op_sel_hi:[1,0,0]
  s_waitcnt lgkmcnt(0)
  s_barrier
  v_fma_mix_f32 v162, v162, v26, v30 op_sel_hi:[1,0,0]
  v_fma_mix_f32 v163, v163, v27, v31 op_sel_hi:[1,0,0]
  s_add_u32 m0, s8, 152576
  s_nop 0
  buffer_load_dwordx4 v3, s[20:23], s55 offen lds
  s_waitcnt vmcnt(15)
  v_fma_mix_f32 v164, v164, v24, v28 op_sel_hi:[1,0,0]
  v_fma_mix_f32 v165, v165, v25, v29 op_sel_hi:[1,0,0]
  v_fma_mix_f32 v166, v166, v26, v30 op_sel_hi:[1,0,0]
  v_fma_mix_f32 v167, v167, v27, v31 op_sel_hi:[1,0,0]
  v_cvt_pk_bf16_f32 v48, v160, v164
  v_lshl_add_u32 v2, s61, 17, v2
  buffer_load_dwordx4 v[96:99], v2, s[24:27], 0 offen
  v_cvt_pk_bf16_f32 v52, v161, v165
  v_cvt_pk_bf16_f32 v56, v162, v166
  v_cvt_pk_bf16_f32 v60, v163, v167
  s_waitcnt vmcnt(15)
  v_fma_mix_f32 v168, v168, v24, v28 op_sel_hi:[1,0,0]
  v_fma_mix_f32 v169, v169, v25, v29 op_sel_hi:[1,0,0]
  buffer_load_dwordx4 v[100:103], v2, s[24:27], s41 offen
  v_fma_mix_f32 v170, v170, v26, v30 op_sel_hi:[1,0,0]
  v_fma_mix_f32 v171, v171, v27, v31 op_sel_hi:[1,0,0]
  s_waitcnt vmcnt(15)
  v_fma_mix_f32 v172, v172, v24, v28 op_sel_hi:[1,0,0]
  v_fma_mix_f32 v173, v173, v25, v29 op_sel_hi:[1,0,0]
  v_fma_mix_f32 v174, v174, v26, v30 op_sel_hi:[1,0,0]
  buffer_load_dwordx4 v[104:107], v2, s[24:27], s42 offen
  v_fma_mix_f32 v175, v175, v27, v31 op_sel_hi:[1,0,0]
  v_cvt_pk_bf16_f32 v49, v168, v172
  v_cvt_pk_bf16_f32 v53, v169, v173
  v_cvt_pk_bf16_f32 v57, v170, v174
  v_cvt_pk_bf16_f32 v61, v171, v175
  buffer_load_dwordx4 v[108:111], v2, s[24:27], s43 offen
  s_waitcnt vmcnt(16)
  v_fma_mix_f32 v176, v176, v24, v28 op_sel_hi:[1,0,0]
  v_fma_mix_f32 v177, v177, v25, v29 op_sel_hi:[1,0,0]
  v_fma_mix_f32 v178, v178, v26, v30 op_sel_hi:[1,0,0]
  v_fma_mix_f32 v179, v179, v27, v31 op_sel_hi:[1,0,0]
  s_waitcnt vmcnt(15)
  v_fma_mix_f32 v180, v180, v24, v28 op_sel_hi:[1,0,0]
  buffer_load_dwordx4 v[112:115], v2, s[24:27], s44 offen
  v_fma_mix_f32 v181, v181, v25, v29 op_sel_hi:[1,0,0]
  v_fma_mix_f32 v182, v182, v26, v30 op_sel_hi:[1,0,0]
  v_fma_mix_f32 v183, v183, v27, v31 op_sel_hi:[1,0,0]
  v_cvt_pk_bf16_f32 v50, v176, v180
  v_cvt_pk_bf16_f32 v54, v177, v181
  buffer_load_dwordx4 v[116:119], v2, s[24:27], s45 offen
  v_cvt_pk_bf16_f32 v58, v178, v182
  v_cvt_pk_bf16_f32 v62, v179, v183
  s_waitcnt vmcnt(16)
  v_fma_mix_f32 v184, v184, v24, v28 op_sel_hi:[1,0,0]
  v_fma_mix_f32 v185, v185, v25, v29 op_sel_hi:[1,0,0]
  v_fma_mix_f32 v186, v186, v26, v30 op_sel_hi:[1,0,0]
  buffer_load_dwordx4 v[120:123], v2, s[24:27], s46 offen
  v_fma_mix_f32 v187, v187, v27, v31 op_sel_hi:[1,0,0]
  s_waitcnt vmcnt(16)
  v_fma_mix_f32 v188, v188, v24, v28 op_sel_hi:[1,0,0]
  v_fma_mix_f32 v189, v189, v25, v29 op_sel_hi:[1,0,0]
  v_fma_mix_f32 v190, v190, v26, v30 op_sel_hi:[1,0,0]
  v_fma_mix_f32 v191, v191, v27, v31 op_sel_hi:[1,0,0]
  buffer_load_dwordx4 v[124:127], v2, s[24:27], s47 offen
  v_cvt_pk_bf16_f32 v51, v184, v188
  v_cvt_pk_bf16_f32 v55, v185, v189
  v_cvt_pk_bf16_f32 v59, v186, v190
  v_cvt_pk_bf16_f32 v63, v187, v191
  ds_read_b128 v[20:23], v5 offset:1536
  ds_write_b128 v7, v[48:51] offset:16384
  v_lshl_add_u32 v3, s69, 7, v3
  s_add_u32 m0, s8, 41984
  s_nop 0
  buffer_load_dwordx4 v3, s[20:23], 0 offen lds
  ds_write_b128 v7, v[52:55] offset:17408
  s_add_u32 m0, s8, 46080
  s_nop 0
  buffer_load_dwordx4 v3, s[20:23], s48 offen lds
  ds_write_b128 v7, v[56:59] offset:18432
  s_add_u32 m0, s8, 50176
  s_nop 0
  buffer_load_dwordx4 v3, s[20:23], s49 offen lds
  ds_write_b128 v7, v[60:63] offset:19456
  s_add_u32 m0, s8, 54272
  s_nop 0
  buffer_load_dwordx4 v3, s[20:23], s50 offen lds
  v_lshl_add_u32 v2, s62, 17, v2
  buffer_load_dwordx4 v[128:131], v2, s[24:27], 0 offen
  buffer_load_dwordx4 v[132:135], v2, s[24:27], s41 offen
  buffer_load_dwordx4 v[136:139], v2, s[24:27], s42 offen
  s_waitcnt lgkmcnt(4)
  v_mul_f32 v28, 0xb5000000, v20
  v_mul_f32 v29, 0xb5000000, v21
  v_mul_f32 v30, 0xb5000000, v22
  v_mul_f32 v31, 0xb5000000, v23
  s_waitcnt vmcnt(14)
  v_fma_mix_f32 v96, v96, v20, v28 op_sel_hi:[1,0,0]
  buffer_load_dwordx4 v[140:143], v2, s[24:27], s43 offen
  v_fma_mix_f32 v97, v97, v21, v29 op_sel_hi:[1,0,0]
  v_fma_mix_f32 v98, v98, v22, v30 op_sel_hi:[1,0,0]
  v_fma_mix_f32 v99, v99, v23, v31 op_sel_hi:[1,0,0]
  s_waitcnt vmcnt(14)
  v_fma_mix_f32 v100, v100, v20, v28 op_sel_hi:[1,0,0]
  v_fma_mix_f32 v101, v101, v21, v29 op_sel_hi:[1,0,0]
  v_fma_mix_f32 v102, v102, v22, v30 op_sel_hi:[1,0,0]
  s_waitcnt lgkmcnt(0)
  s_barrier
  v_fma_mix_f32 v103, v103, v23, v31 op_sel_hi:[1,0,0]
  v_cvt_pk_bf16_f32 v32, v96, v100
  v_cvt_pk_bf16_f32 v36, v97, v101
  v_cvt_pk_bf16_f32 v40, v98, v102
  buffer_load_dwordx4 v[144:147], v2, s[24:27], s44 offen
  v_cvt_pk_bf16_f32 v44, v99, v103
  s_waitcnt vmcnt(14)
  v_fma_mix_f32 v104, v104, v20, v28 op_sel_hi:[1,0,0]
  v_fma_mix_f32 v105, v105, v21, v29 op_sel_hi:[1,0,0]
  v_fma_mix_f32 v106, v106, v22, v30 op_sel_hi:[1,0,0]
  v_fma_mix_f32 v107, v107, v23, v31 op_sel_hi:[1,0,0]
  s_waitcnt vmcnt(13)
  v_fma_mix_f32 v108, v108, v20, v28 op_sel_hi:[1,0,0]
  v_fma_mix_f32 v109, v109, v21, v29 op_sel_hi:[1,0,0]
  v_fma_mix_f32 v110, v110, v22, v30 op_sel_hi:[1,0,0]
  v_fma_mix_f32 v111, v111, v23, v31 op_sel_hi:[1,0,0]
  v_cvt_pk_bf16_f32 v33, v104, v108
  buffer_load_dwordx4 v[148:151], v2, s[24:27], s45 offen
  v_cvt_pk_bf16_f32 v37, v105, v109
  v_cvt_pk_bf16_f32 v41, v106, v110
  v_cvt_pk_bf16_f32 v45, v107, v111
  s_waitcnt vmcnt(13)
  v_fma_mix_f32 v112, v112, v20, v28 op_sel_hi:[1,0,0]
  v_fma_mix_f32 v113, v113, v21, v29 op_sel_hi:[1,0,0]
  v_fma_mix_f32 v114, v114, v22, v30 op_sel_hi:[1,0,0]
  v_fma_mix_f32 v115, v115, v23, v31 op_sel_hi:[1,0,0]
  s_waitcnt vmcnt(12)
  v_fma_mix_f32 v116, v116, v20, v28 op_sel_hi:[1,0,0]
  v_fma_mix_f32 v117, v117, v21, v29 op_sel_hi:[1,0,0]
  v_fma_mix_f32 v118, v118, v22, v30 op_sel_hi:[1,0,0]
  buffer_load_dwordx4 v[152:155], v2, s[24:27], s46 offen
  v_fma_mix_f32 v119, v119, v23, v31 op_sel_hi:[1,0,0]
  v_cvt_pk_bf16_f32 v34, v112, v116
  v_cvt_pk_bf16_f32 v38, v113, v117
  v_cvt_pk_bf16_f32 v42, v114, v118
  v_cvt_pk_bf16_f32 v46, v115, v119
  s_waitcnt vmcnt(12)
  v_fma_mix_f32 v120, v120, v20, v28 op_sel_hi:[1,0,0]
  v_fma_mix_f32 v121, v121, v21, v29 op_sel_hi:[1,0,0]
  v_fma_mix_f32 v122, v122, v22, v30 op_sel_hi:[1,0,0]
  v_fma_mix_f32 v123, v123, v23, v31 op_sel_hi:[1,0,0]
  s_waitcnt vmcnt(11)
  v_fma_mix_f32 v124, v124, v20, v28 op_sel_hi:[1,0,0]
  buffer_load_dwordx4 v[156:159], v2, s[24:27], s47 offen
  v_fma_mix_f32 v125, v125, v21, v29 op_sel_hi:[1,0,0]
  v_fma_mix_f32 v126, v126, v22, v30 op_sel_hi:[1,0,0]
  v_fma_mix_f32 v127, v127, v23, v31 op_sel_hi:[1,0,0]
  v_cvt_pk_bf16_f32 v35, v120, v124
  v_cvt_pk_bf16_f32 v39, v121, v125
  v_cvt_pk_bf16_f32 v43, v122, v126
  v_cvt_pk_bf16_f32 v47, v123, v127
  ds_read_b128 v[24:27], v5 offset:1792
  ds_write_b128 v7, v[32:35] offset:0
  v_lshl_add_u32 v19, s70, 7, v3
  s_add_u32 m0, s8, 80896
  s_nop 0
  buffer_load_dwordx4 v19, s[20:23], 0 offen lds
  ds_write_b128 v7, v[36:39] offset:1024
  ds_write_b128 v7, v[40:43] offset:2048
  s_add_u32 m0, s8, 84992
  s_nop 0
  buffer_load_dwordx4 v19, s[20:23], s48 offen lds
  ds_write_b128 v7, v[44:47] offset:3072
  s_add_u32 m0, s8, 89088
  s_nop 0
  buffer_load_dwordx4 v19, s[20:23], s49 offen lds
  s_waitcnt lgkmcnt(4)
  v_mul_f32 v28, 0xb5000000, v24
  v_mul_f32 v29, 0xb5000000, v25
  v_mul_f32 v30, 0xb5000000, v26
  v_mul_f32 v31, 0xb5000000, v27
  s_waitcnt vmcnt(10)
  v_fma_mix_f32 v128, v128, v24, v28 op_sel_hi:[1,0,0]
  s_add_u32 m0, s8, 93184
  s_nop 0
  buffer_load_dwordx4 v19, s[20:23], s50 offen lds
  v_fma_mix_f32 v129, v129, v25, v29 op_sel_hi:[1,0,0]
  v_fma_mix_f32 v130, v130, v26, v30 op_sel_hi:[1,0,0]
  v_fma_mix_f32 v131, v131, v27, v31 op_sel_hi:[1,0,0]
  s_waitcnt vmcnt(10)
  v_fma_mix_f32 v132, v132, v24, v28 op_sel_hi:[1,0,0]
  v_fma_mix_f32 v133, v133, v25, v29 op_sel_hi:[1,0,0]
  v_fma_mix_f32 v134, v134, v26, v30 op_sel_hi:[1,0,0]
  v_fma_mix_f32 v135, v135, v27, v31 op_sel_hi:[1,0,0]
  v_cvt_pk_bf16_f32 v48, v128, v132
  v_lshl_add_u32 v2, s63, 17, v2
  buffer_load_dwordx4 v[160:163], v2, s[24:27], 0 offen
  v_cvt_pk_bf16_f32 v52, v129, v133
  v_cvt_pk_bf16_f32 v56, v130, v134
  v_cvt_pk_bf16_f32 v60, v131, v135
  s_waitcnt vmcnt(10)
  v_fma_mix_f32 v136, v136, v24, v28 op_sel_hi:[1,0,0]
  v_fma_mix_f32 v137, v137, v25, v29 op_sel_hi:[1,0,0]
  v_fma_mix_f32 v138, v138, v26, v30 op_sel_hi:[1,0,0]
  v_fma_mix_f32 v139, v139, v27, v31 op_sel_hi:[1,0,0]
  s_waitcnt vmcnt(9)
  v_fma_mix_f32 v140, v140, v24, v28 op_sel_hi:[1,0,0]
  buffer_load_dwordx4 v[164:167], v2, s[24:27], s41 offen
  v_fma_mix_f32 v141, v141, v25, v29 op_sel_hi:[1,0,0]
  v_fma_mix_f32 v142, v142, v26, v30 op_sel_hi:[1,0,0]
  v_fma_mix_f32 v143, v143, v27, v31 op_sel_hi:[1,0,0]
  v_cvt_pk_bf16_f32 v49, v136, v140
  v_cvt_pk_bf16_f32 v53, v137, v141
  v_cvt_pk_bf16_f32 v57, v138, v142
  v_cvt_pk_bf16_f32 v61, v139, v143
  s_waitcnt vmcnt(9)
  v_fma_mix_f32 v144, v144, v24, v28 op_sel_hi:[1,0,0]
  v_fma_mix_f32 v145, v145, v25, v29 op_sel_hi:[1,0,0]
  buffer_load_dwordx4 v[168:171], v2, s[24:27], s42 offen
  v_fma_mix_f32 v146, v146, v26, v30 op_sel_hi:[1,0,0]
  v_fma_mix_f32 v147, v147, v27, v31 op_sel_hi:[1,0,0]
  s_waitcnt vmcnt(9)
  v_fma_mix_f32 v148, v148, v24, v28 op_sel_hi:[1,0,0]
  v_fma_mix_f32 v149, v149, v25, v29 op_sel_hi:[1,0,0]
  v_fma_mix_f32 v150, v150, v26, v30 op_sel_hi:[1,0,0]
  v_fma_mix_f32 v151, v151, v27, v31 op_sel_hi:[1,0,0]
  v_cvt_pk_bf16_f32 v50, v144, v148
  v_cvt_pk_bf16_f32 v54, v145, v149
  buffer_load_dwordx4 v[172:175], v2, s[24:27], s43 offen
  v_cvt_pk_bf16_f32 v58, v146, v150
  v_cvt_pk_bf16_f32 v62, v147, v151
  s_waitcnt vmcnt(9)
  v_fma_mix_f32 v152, v152, v24, v28 op_sel_hi:[1,0,0]
  v_fma_mix_f32 v153, v153, v25, v29 op_sel_hi:[1,0,0]
  v_fma_mix_f32 v154, v154, v26, v30 op_sel_hi:[1,0,0]
  v_fma_mix_f32 v155, v155, v27, v31 op_sel_hi:[1,0,0]
  s_waitcnt vmcnt(8)
  v_fma_mix_f32 v156, v156, v24, v28 op_sel_hi:[1,0,0]
  v_fma_mix_f32 v157, v157, v25, v29 op_sel_hi:[1,0,0]
  buffer_load_dwordx4 v[176:179], v2, s[24:27], s44 offen
  v_fma_mix_f32 v158, v158, v26, v30 op_sel_hi:[1,0,0]
  v_fma_mix_f32 v159, v159, v27, v31 op_sel_hi:[1,0,0]
  v_cvt_pk_bf16_f32 v51, v152, v156
  v_cvt_pk_bf16_f32 v55, v153, v157
  v_cvt_pk_bf16_f32 v59, v154, v158
  v_cvt_pk_bf16_f32 v63, v155, v159
  ds_read_b128 v[20:23], v5 offset:2048
  buffer_load_dwordx4 v[180:183], v2, s[24:27], s45 offen
  buffer_load_dwordx4 v[184:187], v2, s[24:27], s46 offen
  buffer_load_dwordx4 v[188:191], v2, s[24:27], s47 offen
  s_waitcnt lgkmcnt(1)
  s_barrier
  ds_write_b128 v7, v[48:51] offset:16384
  v_lshl_add_u32 v18, s71, 7, v19
  s_add_u32 m0, s8, 119808
  s_nop 0
  buffer_load_dwordx4 v18, s[20:23], 0 offen lds
  ds_write_b128 v7, v[52:55] offset:17408
  ds_write_b128 v7, v[56:59] offset:18432
  s_add_u32 m0, s8, 123904
  s_nop 0
  buffer_load_dwordx4 v18, s[20:23], s48 offen lds
  ds_write_b128 v7, v[60:63] offset:19456
  s_waitcnt lgkmcnt(4)
  v_mul_f32 v28, 0xb5000000, v20
  v_mul_f32 v29, 0xb5000000, v21
  v_mul_f32 v30, 0xb5000000, v22
  v_mul_f32 v31, 0xb5000000, v23
  s_waitcnt vmcnt(9)
  v_fma_mix_f32 v160, v160, v20, v28 op_sel_hi:[1,0,0]
  v_fma_mix_f32 v161, v161, v21, v29 op_sel_hi:[1,0,0]
  v_fma_mix_f32 v162, v162, v22, v30 op_sel_hi:[1,0,0]
  s_add_u32 m0, s8, 128000
  s_nop 0
  buffer_load_dwordx4 v18, s[20:23], s49 offen lds
  v_fma_mix_f32 v163, v163, v23, v31 op_sel_hi:[1,0,0]
  s_waitcnt vmcnt(9)
  v_fma_mix_f32 v164, v164, v20, v28 op_sel_hi:[1,0,0]
  v_fma_mix_f32 v165, v165, v21, v29 op_sel_hi:[1,0,0]
  v_fma_mix_f32 v166, v166, v22, v30 op_sel_hi:[1,0,0]
  v_fma_mix_f32 v167, v167, v23, v31 op_sel_hi:[1,0,0]
  v_cvt_pk_bf16_f32 v32, v160, v164
  v_cvt_pk_bf16_f32 v36, v161, v165
  v_cvt_pk_bf16_f32 v40, v162, v166
  v_cvt_pk_bf16_f32 v44, v163, v167
  s_waitcnt vmcnt(8)
  v_fma_mix_f32 v168, v168, v20, v28 op_sel_hi:[1,0,0]
  v_fma_mix_f32 v169, v169, v21, v29 op_sel_hi:[1,0,0]
  v_fma_mix_f32 v170, v170, v22, v30 op_sel_hi:[1,0,0]
  s_add_u32 m0, s8, 132096
  s_nop 0
  buffer_load_dwordx4 v18, s[20:23], s50 offen lds
  v_fma_mix_f32 v171, v171, v23, v31 op_sel_hi:[1,0,0]
  s_waitcnt vmcnt(8)
  v_fma_mix_f32 v172, v172, v20, v28 op_sel_hi:[1,0,0]
  v_fma_mix_f32 v173, v173, v21, v29 op_sel_hi:[1,0,0]
  v_fma_mix_f32 v174, v174, v22, v30 op_sel_hi:[1,0,0]
  v_fma_mix_f32 v175, v175, v23, v31 op_sel_hi:[1,0,0]
  v_cvt_pk_bf16_f32 v33, v168, v172
  v_cvt_pk_bf16_f32 v37, v169, v173
  v_cvt_pk_bf16_f32 v41, v170, v174
  v_cvt_pk_bf16_f32 v45, v171, v175
  s_waitcnt vmcnt(7)
  v_fma_mix_f32 v176, v176, v20, v28 op_sel_hi:[1,0,0]
  v_fma_mix_f32 v177, v177, v21, v29 op_sel_hi:[1,0,0]
  v_fma_mix_f32 v178, v178, v22, v30 op_sel_hi:[1,0,0]
  v_fma_mix_f32 v179, v179, v23, v31 op_sel_hi:[1,0,0]
  s_add_u32 m0, s8, 58368
  s_nop 0
  buffer_load_dwordx4 v3, s[20:23], s51 offen lds
  s_waitcnt vmcnt(7)
  v_fma_mix_f32 v180, v180, v20, v28 op_sel_hi:[1,0,0]
  v_fma_mix_f32 v181, v181, v21, v29 op_sel_hi:[1,0,0]
  v_fma_mix_f32 v182, v182, v22, v30 op_sel_hi:[1,0,0]
  v_fma_mix_f32 v183, v183, v23, v31 op_sel_hi:[1,0,0]
  v_cvt_pk_bf16_f32 v34, v176, v180
  v_cvt_pk_bf16_f32 v38, v177, v181
  v_cvt_pk_bf16_f32 v42, v178, v182
  s_waitcnt lgkmcnt(0)
  s_barrier
  v_cvt_pk_bf16_f32 v46, v179, v183
  s_waitcnt vmcnt(6)
  v_fma_mix_f32 v184, v184, v20, v28 op_sel_hi:[1,0,0]
  v_fma_mix_f32 v185, v185, v21, v29 op_sel_hi:[1,0,0]
  v_fma_mix_f32 v186, v186, v22, v30 op_sel_hi:[1,0,0]
  v_fma_mix_f32 v187, v187, v23, v31 op_sel_hi:[1,0,0]
  s_add_u32 m0, s8, 62464
  s_nop 0
  buffer_load_dwordx4 v3, s[20:23], s52 offen lds
  s_waitcnt vmcnt(6)
  v_fma_mix_f32 v188, v188, v20, v28 op_sel_hi:[1,0,0]
  v_fma_mix_f32 v189, v189, v21, v29 op_sel_hi:[1,0,0]
  v_fma_mix_f32 v190, v190, v22, v30 op_sel_hi:[1,0,0]
  v_fma_mix_f32 v191, v191, v23, v31 op_sel_hi:[1,0,0]
  v_cvt_pk_bf16_f32 v35, v184, v188
  v_cvt_pk_bf16_f32 v39, v185, v189
  v_cvt_pk_bf16_f32 v43, v186, v190
  v_cvt_pk_bf16_f32 v47, v187, v191
  ds_write_b128 v7, v[32:35] offset:37888
  s_add_u32 m0, s8, 66560
  s_nop 0
  buffer_load_dwordx4 v3, s[20:23], s53 offen lds
  ds_write_b128 v7, v[36:39] offset:38912
  ds_write_b128 v7, v[40:43] offset:39936
  s_add_u32 m0, s8, 97280
  s_nop 0
  buffer_load_dwordx4 v19, s[20:23], s51 offen lds
  ds_write_b128 v7, v[44:47] offset:40960
  s_add_u32 m0, s8, 101376
  s_nop 0
  buffer_load_dwordx4 v19, s[20:23], s52 offen lds
  s_add_u32 m0, s8, 105472
  s_nop 0
  buffer_load_dwordx4 v19, s[20:23], s53 offen lds
  s_add_u32 m0, s8, 136192
  s_nop 0
  buffer_load_dwordx4 v18, s[20:23], s51 offen lds
  s_add_u32 m0, s8, 140288
  s_nop 0
  buffer_load_dwordx4 v18, s[20:23], s52 offen lds
  s_add_u32 m0, s8, 144384
  s_nop 0
  buffer_load_dwordx4 v18, s[20:23], s53 offen lds
  s_waitcnt vmcnt(9) lgkmcnt(0)
  s_barrier
  s_add_u32 m0, s8, 70656
  s_nop 0
  buffer_load_dwordx4 v3, s[20:23], s54 offen lds
  s_add_u32 m0, s8, 74752
  s_nop 0
  buffer_load_dwordx4 v3, s[20:23], s55 offen lds
  s_add_u32 m0, s8, 109568
  s_nop 0
  buffer_load_dwordx4 v19, s[20:23], s54 offen lds
  s_add_u32 m0, s8, 113664
  s_nop 0
L_w4b:
  s_cbranch_execz L_wret1b
  buffer_load_dwordx4 v19, s[20:23], s55 offen lds
  s_add_u32 m0, s8, 148480
  s_nop 0
  buffer_load_dwordx4 v18, s[20:23], s54 offen lds
  s_add_u32 m0, s8, 152576
  s_nop 0
  buffer_load_dwordx4 v18, s[20:23], s55 offen lds
  s_waitcnt vmcnt(12)
  s_barrier
  s_waitcnt vmcnt(9)
  s_barrier
  s_waitcnt vmcnt(6)
  s_barrier
  s_waitcnt vmcnt(0)
  s_barrier
  s_endpgm
L_endc0b:
L_cons:
  s_setprio 3
  s_mov_b32 s18, s42
  s_mul_i32 s14, s15, 18
  s_min_u32 s40, s15, 2
  s_add_u32 s14, s14, s40
  s_cmp_lt_u32 s15, 2
  s_cselect_b32 s101, 19, 18
  s_lshl_b32 s40, s3, 12
  v_lshl_add_u32 v7, v1, 4, s40
  v_xor_b32 v8, 0x2000, v7
  s_mul_i32 s40, s100, 147456
  s_lshl1_add_u32 s40, s18, s40
  v_mul_u32_u24 v4, 36864, v65
  v_lshl_add_u32 v4, v64, 3, v4
  v_add_u32 v4, s40, v4
  s_mul_i32 s40, s100, -129024
  s_add_u32 s40, s40, 2654208
  v_add_u32 v0, s40, v4
  v_lshrrev_b32 v71, 1, v64
  v_and_b32 v71, 2, v71
  v_lshlrev_b32 v72, 1, v64
  v_and_b32 v72, 4, v72
  s_lshl_b32 s40, s100, 2
  v_add_u32 v73, s40, v65
  v_xor_b32 v71, v71, v72
  v_xor_b32 v71, v71, v73
  v_lshlrev_b32 v71, 4, v71
  v_lshl_add_u32 v71, v64, 7, v71
  v_add_u32 v18, 78848, v71
  v_add_u32 v19, 156672, v71
  s_lshl_b32 s40, s100, 11
  s_add_u32 s40, s40, 41984
  v_add_u32 v12, s40, v71
  v_xor_b32 v13, 64, v12
  v_add_u32 v14, 38912, v12
  v_add_u32 v15, 38912, v13
  v_add_u32 v16, 77824, v12
  v_add_u32 v17, 77824, v13
  v_add_u32 v10, 80896, v7
  v_and_b32 v9, 0x1fff, v7
  s_lshl_b32 s40, s100, 3
  v_add_u32 v9, s40, v9
  s_waitcnt lgkmcnt(0)
  s_mul_i32 s15, s14, 147456
  s_add_u32 s36, s12, s15
  s_addc_u32 s37, s13, 0
  s_and_b32 s37, s37, 0xffff
  s_mul_i32 s38, s101, 147456
  s_mov_b32 s39, 0x20000
  s_cmp_eq_u32 s101, 18
  s_cbranch_scc1 L_beg1b
L_beg1a:
  s_mov_b64 exec, 0
  s_cmp_eq_u32 s3, 0
  s_cbranch_scc1 L_w1a
  s_cmp_eq_u32 s3, 1
  s_cbranch_scc1 L_w2a
  s_cmp_eq_u32 s3, 2
  s_cbranch_scc1 L_w3a
  s_branch L_w4a
L_wret1a:
  s_mov_b64 exec, -1
  s_barrier
  ds_read_b128 a[0:3], v7 offset:0
  ds_read_b128 a[4:7], v7 offset:1024
  ds_read_b128 a[8:11], v7 offset:2048
  ds_read_b128 a[12:15], v7 offset:3072
  ds_read_b128 a[32:35], v12 offset:0
  ds_read_b128 a[36:39], v12 offset:4096
  ds_read_b128 a[40:43], v12 offset:8192
  ds_read_b128 a[16:19], v8 offset:0
  ds_read_b128 a[20:23], v8 offset:1024
  ds_read_b128 a[24:27], v8 offset:2048
  ds_read_b128 a[28:31], v8 offset:3072
  s_waitcnt lgkmcnt(6)
  v_mfma_f32_16x16x32_bf16 v[32:35], a[32:35], a[0:3], 0
  ds_read_b128 a[44:47], v12 offset:12288
  v_mfma_f32_16x16x32_bf16 v[36:39], a[32:35], a[4:7], 0
  v_mfma_f32_16x16x32_bf16 v[40:43], a[32:35], a[8:11], 0
  v_mfma_f32_16x16x32_bf16 v[44:47], a[32:35], a[12:15], 0
  s_waitcnt lgkmcnt(6)
  v_mfma_f32_16x16x32_bf16 v[48:51], a[36:39], a[0:3], 0
  ds_read_b128 a[48:51], v12 offset:16384
  v_mfma_f32_16x16x32_bf16 v[52:55], a[36:39], a[4:7], 0
  v_mfma_f32_16x16x32_bf16 v[56:59], a[36:39], a[8:11], 0
  v_mfma_f32_16x16x32_bf16 v[60:63], a[36:39], a[12:15], 0
  s_waitcnt lgkmcnt(6)
  v_mfma_f32_16x16x32_bf16 v[64:67], a[40:43], a[0:3], 0
  ds_read_b128 a[52:55], v12 offset:20480
  v_mfma_f32_16x16x32_bf16 v[68:71], a[40:43], a[4:7], 0
  v_mfma_f32_16x16x32_bf16 v[72:75], a[40:43], a[8:11], 0
  v_mfma_f32_16x16x32_bf16 v[76:79], a[40:43], a[12:15], 0
  s_waitcnt lgkmcnt(2)
  v_mfma_f32_16x16x32_bf16 v[80:83], a[44:47], a[0:3], 0
  ds_read_b128 a[56:59], v12 offset:24576
  v_mfma_f32_16x16x32_bf16 v[84:87], a[44:47], a[4:7], 0
  v_mfma_f32_16x16x32_bf16 v[88:91], a[44:47], a[8:11], 0
  s_waitcnt vmcnt(0)
  v_mfma_f32_16x16x32_bf16 v[92:95], a[44:47], a[12:15], 0
  s_waitcnt lgkmcnt(2)
  v_mfma_f32_16x16x32_bf16 v[96:99], a[48:51], a[0:3], 0
  ds_read_b128 a[60:63], v12 offset:28672
  v_mfma_f32_16x16x32_bf16 v[100:103], a[48:51], a[4:7], 0
  v_mfma_f32_16x16x32_bf16 v[104:107], a[48:51], a[8:11], 0
  v_mfma_f32_16x16x32_bf16 v[108:111], a[48:51], a[12:15], 0
  s_waitcnt lgkmcnt(2)
  v_mfma_f32_16x16x32_bf16 v[112:115], a[52:55], a[0:3], 0
  ds_read_b128 a[32:35], v12 offset:32768
  v_mfma_f32_16x16x32_bf16 v[116:119], a[52:55], a[4:7], 0
  v_mfma_f32_16x16x32_bf16 v[120:123], a[52:55], a[8:11], 0
  v_mfma_f32_16x16x32_bf16 v[124:127], a[52:55], a[12:15], 0
  s_waitcnt lgkmcnt(2)
  v_mfma_f32_16x16x32_bf16 v[128:131], a[56:59], a[0:3], 0
  ds_read_b128 a[36:39], v18 offset:0
  v_mfma_f32_16x16x32_bf16 v[132:135], a[56:59], a[4:7], 0
  v_mfma_f32_16x16x32_bf16 v[136:139], a[56:59], a[8:11], 0
  v_mfma_f32_16x16x32_bf16 v[140:143], a[56:59], a[12:15], 0
  s_waitcnt lgkmcnt(2)
  v_mfma_f32_16x16x32_bf16 v[144:147], a[60:63], a[0:3], 0
  ds_read_b128 a[40:43], v13 offset:0
  v_mfma_f32_16x16x32_bf16 v[148:151], a[60:63], a[4:7], 0
  v_mfma_f32_16x16x32_bf16 v[152:155], a[60:63], a[8:11], 0
  v_mfma_f32_16x16x32_bf16 v[156:159], a[60:63], a[12:15], 0
  s_waitcnt lgkmcnt(2)
  v_mfma_f32_16x16x32_bf16 v[160:163], a[32:35], a[0:3], 0
  ds_read_b128 a[44:47], v13 offset:4096
  v_mfma_f32_16x16x32_bf16 v[164:167], a[32:35], a[4:7], 0
  v_mfma_f32_16x16x32_bf16 v[168:171], a[32:35], a[8:11], 0
  v_mfma_f32_16x16x32_bf16 v[172:175], a[32:35], a[12:15], 0
  s_waitcnt lgkmcnt(2)
  v_mfma_f32_16x16x32_bf16 v[176:179], a[36:39], a[0:3], 0
  ds_read_b128 a[48:51], v13 offset:8192
  v_mfma_f32_16x16x32_bf16 v[180:183], a[36:39], a[4:7], 0
  v_mfma_f32_16x16x32_bf16 v[184:187], a[36:39], a[8:11], 0
  v_mfma_f32_16x16x32_bf16 v[188:191], a[36:39], a[12:15], 0
  s_waitcnt lgkmcnt(2)
  v_mfma_f32_16x16x32_bf16 v[32:35], a[40:43], a[16:19], v[32:35]
  ds_read_b128 a[52:55], v13 offset:12288
  v_mfma_f32_16x16x32_bf16 v[36:39], a[40:43], a[20:23], v[36:39]
  v_mfma_f32_16x16x32_bf16 v[40:43], a[40:43], a[24:27], v[40:43]
  v_mfma_f32_16x16x32_bf16 v[44:47], a[40:43], a[28:31], v[44:47]
  s_waitcnt lgkmcnt(2)
  v_mfma_f32_16x16x32_bf16 v[48:51], a[44:47], a[16:19], v[48:51]
  ds_read_b128 a[56:59], v13 offset:16384
  v_mfma_f32_16x16x32_bf16 v[52:55], a[44:47], a[20:23], v[52:55]
  v_mfma_f32_16x16x32_bf16 v[56:59], a[44:47], a[24:27], v[56:59]
  v_mfma_f32_16x16x32_bf16 v[60:63], a[44:47], a[28:31], v[60:63]
  s_waitcnt lgkmcnt(2)
  v_mfma_f32_16x16x32_bf16 v[64:67], a[48:51], a[16:19], v[64:67]
  ds_read_b128 a[60:63], v13 offset:20480
  v_mfma_f32_16x16x32_bf16 v[68:71], a[48:51], a[20:23], v[68:71]
  v_mfma_f32_16x16x32_bf16 v[72:75], a[48:51], a[24:27], v[72:75]
  v_mfma_f32_16x16x32_bf16 v[76:79], a[48:51], a[28:31], v[76:79]
  s_waitcnt lgkmcnt(2)
  v_mfma_f32_16x16x32_bf16 v[80:83], a[52:55], a[16:19], v[80:83]
  ds_read_b128 a[32:35], v13 offset:24576
  v_mfma_f32_16x16x32_bf16 v[84:87], a[52:55], a[20:23], v[84:87]
  v_mfma_f32_16x16x32_bf16 v[88:91], a[52:55], a[24:27], v[88:91]
  v_mfma_f32_16x16x32_bf16 v[92:95], a[52:55], a[28:31], v[92:95]
  s_waitcnt lgkmcnt(2)
  v_mfma_f32_16x16x32_bf16 v[96:99], a[56:59], a[16:19], v[96:99]
  ds_read_b128 a[36:39], v13 offset:28672
  ds_read_b128 a[40:43], v13 offset:32768
  v_mfma_f32_16x16x32_bf16 v[100:103], a[56:59], a[20:23], v[100:103]
  v_mfma_f32_16x16x32_bf16 v[104:107], a[56:59], a[24:27], v[104:107]
  v_mfma_f32_16x16x32_bf16 v[108:111], a[56:59], a[28:31], v[108:111]
  s_waitcnt lgkmcnt(3)
  v_mfma_f32_16x16x32_bf16 v[112:115], a[60:63], a[16:19], v[112:115]
  v_mfma_f32_16x16x32_bf16 v[116:119], a[60:63], a[20:23], v[116:119]
  v_mfma_f32_16x16x32_bf16 v[120:123], a[60:63], a[24:27], v[120:123]
  s_waitcnt lgkmcnt(0)
  s_barrier
  ds_read_b128 a[0:3], v7 offset:16384
  v_mfma_f32_16x16x32_bf16 v[124:127], a[60:63], a[28:31], v[124:127]
  ds_read_b128 a[4:7], v7 offset:17408
  ds_read_b128 a[8:11], v7 offset:18432
  v_mfma_f32_16x16x32_bf16 v[128:131], a[32:35], a[16:19], v[128:131]
  ds_read_b128 a[12:15], v7 offset:19456
  ds_read_b128 a[44:47], v14 offset:0
  v_mfma_f32_16x16x32_bf16 v[132:135], a[32:35], a[20:23], v[132:135]
  v_mfma_f32_16x16x32_bf16 v[136:139], a[32:35], a[24:27], v[136:139]
  v_mfma_f32_16x16x32_bf16 v[140:143], a[32:35], a[28:31], v[140:143]
  v_mfma_f32_16x16x32_bf16 v[144:147], a[36:39], a[16:19], v[144:147]
  ds_read_b128 a[48:51], v14 offset:4096
  v_mfma_f32_16x16x32_bf16 v[148:151], a[36:39], a[20:23], v[148:151]
  v_mfma_f32_16x16x32_bf16 v[152:155], a[36:39], a[24:27], v[152:155]
  v_mfma_f32_16x16x32_bf16 v[156:159], a[36:39], a[28:31], v[156:159]
  v_mfma_f32_16x16x32_bf16 v[160:163], a[40:43], a[16:19], v[160:163]
  ds_read_b128 a[52:55], v14 offset:8192
  ds_read_b128 a[16:19], v8 offset:16384
  v_mfma_f32_16x16x32_bf16 v[164:167], a[40:43], a[20:23], v[164:167]
  ds_read_b128 a[20:23], v8 offset:17408
  v_mfma_f32_16x16x32_bf16 v[168:171], a[40:43], a[24:27], v[168:171]
  ds_read_b128 a[24:27], v8 offset:18432
  v_mfma_f32_16x16x32_bf16 v[172:175], a[40:43], a[28:31], v[172:175]
  s_waitcnt lgkmcnt(5)
  ds_read_b128 a[28:31], v8 offset:19456
  v_mfma_f32_16x16x32_bf16 v[32:35], a[44:47], a[0:3], v[32:35]
  ds_read_b128 a[56:59], v14 offset:12288
  v_mfma_f32_16x16x32_bf16 v[36:39], a[44:47], a[4:7], v[36:39]
  v_mfma_f32_16x16x32_bf16 v[40:43], a[44:47], a[8:11], v[40:43]
  v_mfma_f32_16x16x32_bf16 v[44:47], a[44:47], a[12:15], v[44:47]
  s_waitcnt lgkmcnt(6)
  v_mfma_f32_16x16x32_bf16 v[48:51], a[48:51], a[0:3], v[48:51]
  ds_read_b128 a[60:63], v14 offset:16384
  v_mfma_f32_16x16x32_bf16 v[52:55], a[48:51], a[4:7], v[52:55]
  v_mfma_f32_16x16x32_bf16 v[56:59], a[48:51], a[8:11], v[56:59]
  v_mfma_f32_16x16x32_bf16 v[60:63], a[48:51], a[12:15], v[60:63]
  s_waitcnt lgkmcnt(6)
  v_mfma_f32_16x16x32_bf16 v[64:67], a[52:55], a[0:3], v[64:67]
  ds_read_b128 a[32:35], v14 offset:20480
  v_mfma_f32_16x16x32_bf16 v[68:71], a[52:55], a[4:7], v[68:71]
  v_mfma_f32_16x16x32_bf16 v[72:75], a[52:55], a[8:11], v[72:75]
  v_mfma_f32_16x16x32_bf16 v[76:79], a[52:55], a[12:15], v[76:79]
  s_waitcnt lgkmcnt(2)
  v_mfma_f32_16x16x32_bf16 v[80:83], a[56:59], a[0:3], v[80:83]
  ds_read_b128 a[36:39], v14 offset:24576
  v_mfma_f32_16x16x32_bf16 v[84:87], a[56:59], a[4:7], v[84:87]
  v_mfma_f32_16x16x32_bf16 v[88:91], a[56:59], a[8:11], v[88:91]
  v_mfma_f32_16x16x32_bf16 v[92:95], a[56:59], a[12:15], v[92:95]
  s_waitcnt lgkmcnt(2)
  v_mfma_f32_16x16x32_bf16 v[96:99], a[60:63], a[0:3], v[96:99]
  ds_read_b128 a[40:43], v14 offset:28672
  v_mfma_f32_16x16x32_bf16 v[100:103], a[60:63], a[4:7], v[100:103]
  v_mfma_f32_16x16x32_bf16 v[104:107], a[60:63], a[8:11], v[104:107]
  v_mfma_f32_16x16x32_bf16 v[108:111], a[60:63], a[12:15], v[108:111]
  s_waitcnt lgkmcnt(2)
  v_mfma_f32_16x16x32_bf16 v[112:115], a[32:35], a[0:3], v[112:115]
  ds_read_b128 a[44:47], v14 offset:32768
  v_mfma_f32_16x16x32_bf16 v[116:119], a[32:35], a[4:7], v[116:119]
  v_mfma_f32_16x16x32_bf16 v[120:123], a[32:35], a[8:11], v[120:123]
  v_mfma_f32_16x16x32_bf16 v[124:127], a[32:35], a[12:15], v[124:127]
  s_waitcnt lgkmcnt(2)
  v_mfma_f32_16x16x32_bf16 v[128:131], a[36:39], a[0:3], v[128:131]
  ds_read_b128 a[48:51], v18 offset:38912
  v_mfma_f32_16x16x32_bf16 v[132:135], a[36:39], a[4:7], v[132:135]
  v_mfma_f32_16x16x32_bf16 v[136:139], a[36:39], a[8:11], v[136:139]
  v_mfma_f32_16x16x32_bf16 v[140:143], a[36:39], a[12:15], v[140:143]
  s_waitcnt lgkmcnt(2)
  v_mfma_f32_16x16x32_bf16 v[144:147], a[40:43], a[0:3], v[144:147]
  ds_read_b128 a[52:55], v15 offset:0
  v_mfma_f32_16x16x32_bf16 v[148:151], a[40:43], a[4:7], v[148:151]
  v_mfma_f32_16x16x32_bf16 v[152:155], a[40:43], a[8:11], v[152:155]
  v_mfma_f32_16x16x32_bf16 v[156:159], a[40:43], a[12:15], v[156:159]
  s_waitcnt lgkmcnt(2)
  v_mfma_f32_16x16x32_bf16 v[160:163], a[44:47], a[0:3], v[160:163]
  ds_read_b128 a[56:59], v15 offset:4096
  v_mfma_f32_16x16x32_bf16 v[164:167], a[44:47], a[4:7], v[164:167]
  v_mfma_f32_16x16x32_bf16 v[168:171], a[44:47], a[8:11], v[168:171]
  v_mfma_f32_16x16x32_bf16 v[172:175], a[44:47], a[12:15], v[172:175]
  s_waitcnt lgkmcnt(2)
  v_mfma_f32_16x16x32_bf16 v[176:179], a[48:51], a[0:3], v[176:179]
  ds_read_b128 a[60:63], v15 offset:8192
  v_mfma_f32_16x16x32_bf16 v[180:183], a[48:51], a[4:7], v[180:183]
  v_mfma_f32_16x16x32_bf16 v[184:187], a[48:51], a[8:11], v[184:187]
  v_mfma_f32_16x16x32_bf16 v[188:191], a[48:51], a[12:15], v[188:191]
  s_waitcnt lgkmcnt(2)
  v_mfma_f32_16x16x32_bf16 v[32:35], a[52:55], a[16:19], v[32:35]
  ds_read_b128 a[32:35], v15 offset:12288
  v_mfma_f32_16x16x32_bf16 v[36:39], a[52:55], a[20:23], v[36:39]
  v_mfma_f32_16x16x32_bf16 v[40:43], a[52:55], a[24:27], v[40:43]
  v_mfma_f32_16x16x32_bf16 v[44:47], a[52:55], a[28:31], v[44:47]
  s_waitcnt lgkmcnt(2)
  v_mfma_f32_16x16x32_bf16 v[48:51], a[56:59], a[16:19], v[48:51]
  ds_read_b128 a[36:39], v15 offset:16384
  v_mfma_f32_16x16x32_bf16 v[52:55], a[56:59], a[20:23], v[52:55]
  v_mfma_f32_16x16x32_bf16 v[56:59], a[56:59], a[24:27], v[56:59]
  v_mfma_f32_16x16x32_bf16 v[60:63], a[56:59], a[28:31], v[60:63]
  s_waitcnt lgkmcnt(2)
  v_mfma_f32_16x16x32_bf16 v[64:67], a[60:63], a[16:19], v[64:67]
  ds_read_b128 a[40:43], v15 offset:20480
  v_mfma_f32_16x16x32_bf16 v[68:71], a[60:63], a[20:23], v[68:71]
  v_mfma_f32_16x16x32_bf16 v[72:75], a[60:63], a[24:27], v[72:75]
  v_mfma_f32_16x16x32_bf16 v[76:79], a[60:63], a[28:31], v[76:79]
  s_waitcnt lgkmcnt(2)
  v_mfma_f32_16x16x32_bf16 v[80:83], a[32:35], a[16:19], v[80:83]
  ds_read_b128 a[44:47], v15 offset:24576
  v_mfma_f32_16x16x32_bf16 v[84:87], a[32:35], a[20:23], v[84:87]
  v_mfma_f32_16x16x32_bf16 v[88:91], a[32:35], a[24:27], v[88:91]
  v_mfma_f32_16x16x32_bf16 v[92:95], a[32:35], a[28:31], v[92:95]
  s_waitcnt lgkmcnt(2)
  v_mfma_f32_16x16x32_bf16 v[96:99], a[36:39], a[16:19], v[96:99]
  ds_read_b128 a[48:51], v15 offset:28672
  ds_read_b128 a[52:55], v15 offset:32768
  v_mfma_f32_16x16x32_bf16 v[100:103], a[36:39], a[20:23], v[100:103]
  v_mfma_f32_16x16x32_bf16 v[104:107], a[36:39], a[24:27], v[104:107]
  v_mfma_f32_16x16x32_bf16 v[108:111], a[36:39], a[28:31], v[108:111]
  s_waitcnt lgkmcnt(3)
  v_mfma_f32_16x16x32_bf16 v[112:115], a[40:43], a[16:19], v[112:115]
  v_mfma_f32_16x16x32_bf16 v[116:119], a[40:43], a[20:23], v[116:119]
  v_mfma_f32_16x16x32_bf16 v[120:123], a[40:43], a[24:27], v[120:123]
  s_waitcnt lgkmcnt(0)
  s_barrier
  ds_read_b128 a[0:3], v7 offset:0
  v_mfma_f32_16x16x32_bf16 v[124:127], a[40:43], a[28:31], v[124:127]
  ds_read_b128 a[4:7], v7 offset:1024
  ds_read_b128 a[8:11], v7 offset:2048
  v_mfma_f32_16x16x32_bf16 v[128:131], a[44:47], a[16:19], v[128:131]
  ds_read_b128 a[12:15], v7 offset:3072
  ds_read_b128 a[56:59], v16 offset:0
  v_mfma_f32_16x16x32_bf16 v[132:135], a[44:47], a[20:23], v[132:135]
  v_mfma_f32_16x16x32_bf16 v[136:139], a[44:47], a[24:27], v[136:139]
  v_mfma_f32_16x16x32_bf16 v[140:143], a[44:47], a[28:31], v[140:143]
  v_mfma_f32_16x16x32_bf16 v[144:147], a[48:51], a[16:19], v[144:147]
  ds_read_b128 a[60:63], v16 offset:4096
  v_mfma_f32_16x16x32_bf16 v[148:151], a[48:51], a[20:23], v[148:151]
  v_mfma_f32_16x16x32_bf16 v[152:155], a[48:51], a[24:27], v[152:155]
  v_mfma_f32_16x16x32_bf16 v[156:159], a[48:51], a[28:31], v[156:159]
  v_mfma_f32_16x16x32_bf16 v[160:163], a[52:55], a[16:19], v[160:163]
  ds_read_b128 a[32:35], v16 offset:8192
  ds_read_b128 a[16:19], v8 offset:0
  v_mfma_f32_16x16x32_bf16 v[164:167], a[52:55], a[20:23], v[164:167]
  ds_read_b128 a[20:23], v8 offset:1024
  v_mfma_f32_16x16x32_bf16 v[168:171], a[52:55], a[24:27], v[168:171]
  ds_read_b128 a[24:27], v8 offset:2048
  v_mfma_f32_16x16x32_bf16 v[172:175], a[52:55], a[28:31], v[172:175]
  s_waitcnt lgkmcnt(5)
  ds_read_b128 a[28:31], v8 offset:3072
  v_mfma_f32_16x16x32_bf16 v[32:35], a[56:59], a[0:3], v[32:35]
  ds_read_b128 a[36:39], v16 offset:12288
  v_mfma_f32_16x16x32_bf16 v[36:39], a[56:59], a[4:7], v[36:39]
  v_mfma_f32_16x16x32_bf16 v[40:43], a[56:59], a[8:11], v[40:43]
  v_mfma_f32_16x16x32_bf16 v[44:47], a[56:59], a[12:15], v[44:47]
  s_waitcnt lgkmcnt(6)
  v_mfma_f32_16x16x32_bf16 v[48:51], a[60:63], a[0:3], v[48:51]
  ds_read_b128 a[40:43], v16 offset:16384
  v_mfma_f32_16x16x32_bf16 v[52:55], a[60:63], a[4:7], v[52:55]
  v_mfma_f32_16x16x32_bf16 v[56:59], a[60:63], a[8:11], v[56:59]
  v_mfma_f32_16x16x32_bf16 v[60:63], a[60:63], a[12:15], v[60:63]
  s_waitcnt lgkmcnt(6)
  v_mfma_f32_16x16x32_bf16 v[64:67], a[32:35], a[0:3], v[64:67]
  ds_read_b128 a[44:47], v16 offset:20480
  v_mfma_f32_16x16x32_bf16 v[68:71], a[32:35], a[4:7], v[68:71]
  v_mfma_f32_16x16x32_bf16 v[72:75], a[32:35], a[8:11], v[72:75]
  v_mfma_f32_16x16x32_bf16 v[76:79], a[32:35], a[12:15], v[76:79]
  s_waitcnt lgkmcnt(2)
  v_mfma_f32_16x16x32_bf16 v[80:83], a[36:39], a[0:3], v[80:83]
  ds_read_b128 a[48:51], v16 offset:24576
  v_mfma_f32_16x16x32_bf16 v[84:87], a[36:39], a[4:7], v[84:87]
  v_mfma_f32_16x16x32_bf16 v[88:91], a[36:39], a[8:11], v[88:91]
  v_mfma_f32_16x16x32_bf16 v[92:95], a[36:39], a[12:15], v[92:95]
  s_waitcnt lgkmcnt(2)
  v_mfma_f32_16x16x32_bf16 v[96:99], a[40:43], a[0:3], v[96:99]
  ds_read_b128 a[52:55], v16 offset:28672
  v_mfma_f32_16x16x32_bf16 v[100:103], a[40:43], a[4:7], v[100:103]
  v_mfma_f32_16x16x32_bf16 v[104:107], a[40:43], a[8:11], v[104:107]
  v_mfma_f32_16x16x32_bf16 v[108:111], a[40:43], a[12:15], v[108:111]
  s_waitcnt lgkmcnt(2)
  v_mfma_f32_16x16x32_bf16 v[112:115], a[44:47], a[0:3], v[112:115]
  ds_read_b128 a[56:59], v16 offset:32768
  v_mfma_f32_16x16x32_bf16 v[116:119], a[44:47], a[4:7], v[116:119]
  v_mfma_f32_16x16x32_bf16 v[120:123], a[44:47], a[8:11], v[120:123]
  v_mfma_f32_16x16x32_bf16 v[124:127], a[44:47], a[12:15], v[124:127]
  s_waitcnt lgkmcnt(2)
  v_mfma_f32_16x16x32_bf16 v[128:131], a[48:51], a[0:3], v[128:131]
  ds_read_b128 a[60:63], v19 offset:0
  v_mfma_f32_16x16x32_bf16 v[132:135], a[48:51], a[4:7], v[132:135]
  v_mfma_f32_16x16x32_bf16 v[136:139], a[48:51], a[8:11], v[136:139]
  v_mfma_f32_16x16x32_bf16 v[140:143], a[48:51], a[12:15], v[140:143]
  s_waitcnt lgkmcnt(2)
  v_mfma_f32_16x16x32_bf16 v[144:147], a[52:55], a[0:3], v[144:147]
  ds_read_b128 a[32:35], v17 offset:0
  v_mfma_f32_16x16x32_bf16 v[148:151], a[52:55], a[4:7], v[148:151]
  v_mfma_f32_16x16x32_bf16 v[152:155], a[52:55], a[8:11], v[152:155]
  v_mfma_f32_16x16x32_bf16 v[156:159], a[52:55], a[12:15], v[156:159]
  s_waitcnt lgkmcnt(2)
  v_mfma_f32_16x16x32_bf16 v[160:163], a[56:59], a[0:3], v[160:163]
  ds_read_b128 a[36:39], v17 offset:4096
  v_mfma_f32_16x16x32_bf16 v[164:167], a[56:59], a[4:7], v[164:167]
  v_mfma_f32_16x16x32_bf16 v[168:171], a[56:59], a[8:11], v[168:171]
  v_mfma_f32_16x16x32_bf16 v[172:175], a[56:59], a[12:15], v[172:175]
  s_waitcnt lgkmcnt(2)
  v_mfma_f32_16x16x32_bf16 v[176:179], a[60:63], a[0:3], v[176:179]
  ds_read_b128 a[40:43], v17 offset:8192
  v_mfma_f32_16x16x32_bf16 v[180:183], a[60:63], a[4:7], v[180:183]
  v_mfma_f32_16x16x32_bf16 v[184:187], a[60:63], a[8:11], v[184:187]
  v_mfma_f32_16x16x32_bf16 v[188:191], a[60:63], a[12:15], v[188:191]
  s_waitcnt lgkmcnt(2)
  v_mfma_f32_16x16x32_bf16 v[32:35], a[32:35], a[16:19], v[32:35]
  ds_read_b128 a[44:47], v17 offset:12288
  v_mfma_f32_16x16x32_bf16 v[36:39], a[32:35], a[20:23], v[36:39]
  v_mfma_f32_16x16x32_bf16 v[40:43], a[32:35], a[24:27], v[40:43]
  v_mfma_f32_16x16x32_bf16 v[44:47], a[32:35], a[28:31], v[44:47]
  s_waitcnt lgkmcnt(2)
  v_mfma_f32_16x16x32_bf16 v[48:51], a[36:39], a[16:19], v[48:51]
  ds_read_b128 a[48:51], v17 offset:16384
  v_mfma_f32_16x16x32_bf16 v[52:55], a[36:39], a[20:23], v[52:55]
  v_mfma_f32_16x16x32_bf16 v[56:59], a[36:39], a[24:27], v[56:59]
  v_mfma_f32_16x16x32_bf16 v[60:63], a[36:39], a[28:31], v[60:63]
  s_waitcnt lgkmcnt(2)
  v_mfma_f32_16x16x32_bf16 v[64:67], a[40:43], a[16:19], v[64:67]
  ds_read_b128 a[52:55], v17 offset:20480
  v_mfma_f32_16x16x32_bf16 v[68:71], a[40:43], a[20:23], v[68:71]
  v_mfma_f32_16x16x32_bf16 v[72:75], a[40:43], a[24:27], v[72:75]
  v_mfma_f32_16x16x32_bf16 v[76:79], a[40:43], a[28:31], v[76:79]
  s_waitcnt lgkmcnt(2)
  v_mfma_f32_16x16x32_bf16 v[80:83], a[44:47], a[16:19], v[80:83]
  ds_read_b128 a[56:59], v17 offset:24576
  v_mfma_f32_16x16x32_bf16 v[84:87], a[44:47], a[20:23], v[84:87]
  v_mfma_f32_16x16x32_bf16 v[88:91], a[44:47], a[24:27], v[88:91]
  v_mfma_f32_16x16x32_bf16 v[92:95], a[44:47], a[28:31], v[92:95]
  s_waitcnt lgkmcnt(2)
  v_mfma_f32_16x16x32_bf16 v[96:99], a[48:51], a[16:19], v[96:99]
  ds_read_b128 a[60:63], v17 offset:28672
  ds_read_b128 a[32:35], v17 offset:32768
  v_mfma_f32_16x16x32_bf16 v[100:103], a[48:51], a[20:23], v[100:103]
  v_mfma_f32_16x16x32_bf16 v[104:107], a[48:51], a[24:27], v[104:107]
  v_mfma_f32_16x16x32_bf16 v[108:111], a[48:51], a[28:31], v[108:111]
  s_waitcnt lgkmcnt(3)
  v_mfma_f32_16x16x32_bf16 v[112:115], a[52:55], a[16:19], v[112:115]
  v_mfma_f32_16x16x32_bf16 v[116:119], a[52:55], a[20:23], v[116:119]
  v_mfma_f32_16x16x32_bf16 v[120:123], a[52:55], a[24:27], v[120:123]
  s_waitcnt lgkmcnt(0)
  s_barrier
  ds_read_b128 a[0:3], v7 offset:16384
  v_mfma_f32_16x16x32_bf16 v[124:127], a[52:55], a[28:31], v[124:127]
  ds_read_b128 a[4:7], v7 offset:17408
  ds_read_b128 a[8:11], v7 offset:18432
  v_mfma_f32_16x16x32_bf16 v[128:131], a[56:59], a[16:19], v[128:131]
  ds_read_b128 a[12:15], v7 offset:19456
  ds_read_b128 a[36:39], v12 offset:0
  v_mfma_f32_16x16x32_bf16 v[132:135], a[56:59], a[20:23], v[132:135]
  v_mfma_f32_16x16x32_bf16 v[136:139], a[56:59], a[24:27], v[136:139]
  v_mfma_f32_16x16x32_bf16 v[140:143], a[56:59], a[28:31], v[140:143]
  v_mfma_f32_16x16x32_bf16 v[144:147], a[60:63], a[16:19], v[144:147]
  ds_read_b128 a[40:43], v12 offset:4096
  v_mfma_f32_16x16x32_bf16 v[148:151], a[60:63], a[20:23], v[148:151]
  v_mfma_f32_16x16x32_bf16 v[152:155], a[60:63], a[24:27], v[152:155]
  v_mfma_f32_16x16x32_bf16 v[156:159], a[60:63], a[28:31], v[156:159]
  v_mfma_f32_16x16x32_bf16 v[160:163], a[32:35], a[16:19], v[160:163]
  ds_read_b128 a[44:47], v12 offset:8192
  ds_read_b128 a[16:19], v8 offset:16384
  v_mfma_f32_16x16x32_bf16 v[164:167], a[32:35], a[20:23], v[164:167]
  ds_read_b128 a[20:23], v8 offset:17408
  v_mfma_f32_16x16x32_bf16 v[168:171], a[32:35], a[24:27], v[168:171]
  ds_read_b128 a[24:27], v8 offset:18432
  v_mfma_f32_16x16x32_bf16 v[172:175], a[32:35], a[28:31], v[172:175]
  s_waitcnt lgkmcnt(5)
  ds_read_b128 a[28:31], v8 offset:19456
  v_mfma_f32_16x16x32_bf16 v[32:35], a[36:39], a[0:3], v[32:35]
  ds_read_b128 a[48:51], v12 offset:12288
  v_mfma_f32_16x16x32_bf16 v[36:39], a[36:39], a[4:7], v[36:39]
  v_mfma_f32_16x16x32_bf16 v[40:43], a[36:39], a[8:11], v[40:43]
  v_mfma_f32_16x16x32_bf16 v[44:47], a[36:39], a[12:15], v[44:47]
  s_waitcnt lgkmcnt(6)
  v_mfma_f32_16x16x32_bf16 v[48:51], a[40:43], a[0:3], v[48:51]
  ds_read_b128 a[52:55], v12 offset:16384
  v_mfma_f32_16x16x32_bf16 v[52:55], a[40:43], a[4:7], v[52:55]
  v_mfma_f32_16x16x32_bf16 v[56:59], a[40:43], a[8:11], v[56:59]
  v_mfma_f32_16x16x32_bf16 v[60:63], a[40:43], a[12:15], v[60:63]
  s_waitcnt lgkmcnt(6)
  v_mfma_f32_16x16x32_bf16 v[64:67], a[44:47], a[0:3], v[64:67]
  ds_read_b128 a[56:59], v12 offset:20480
  v_mfma_f32_16x16x32_bf16 v[68:71], a[44:47], a[4:7], v[68:71]
  v_mfma_f32_16x16x32_bf16 v[72:75], a[44:47], a[8:11], v[72:75]
  v_mfma_f32_16x16x32_bf16 v[76:79], a[44:47], a[12:15], v[76:79]
  s_waitcnt lgkmcnt(2)
  v_mfma_f32_16x16x32_bf16 v[80:83], a[48:51], a[0:3], v[80:83]
  ds_read_b128 a[60:63], v12 offset:24576
  v_mfma_f32_16x16x32_bf16 v[84:87], a[48:51], a[4:7], v[84:87]
  v_mfma_f32_16x16x32_bf16 v[88:91], a[48:51], a[8:11], v[88:91]
  v_mfma_f32_16x16x32_bf16 v[92:95], a[48:51], a[12:15], v[92:95]
  s_waitcnt lgkmcnt(2)
  v_mfma_f32_16x16x32_bf16 v[96:99], a[52:55], a[0:3], v[96:99]
  ds_read_b128 a[32:35], v12 offset:28672
  v_mfma_f32_16x16x32_bf16 v[100:103], a[52:55], a[4:7], v[100:103]
  v_mfma_f32_16x16x32_bf16 v[104:107], a[52:55], a[8:11], v[104:107]
  v_mfma_f32_16x16x32_bf16 v[108:111], a[52:55], a[12:15], v[108:111]
  s_waitcnt lgkmcnt(2)
  v_mfma_f32_16x16x32_bf16 v[112:115], a[56:59], a[0:3], v[112:115]
  ds_read_b128 a[36:39], v12 offset:32768
  v_mfma_f32_16x16x32_bf16 v[116:119], a[56:59], a[4:7], v[116:119]
  v_mfma_f32_16x16x32_bf16 v[120:123], a[56:59], a[8:11], v[120:123]
  v_mfma_f32_16x16x32_bf16 v[124:127], a[56:59], a[12:15], v[124:127]
  s_waitcnt lgkmcnt(2)
  v_mfma_f32_16x16x32_bf16 v[128:131], a[60:63], a[0:3], v[128:131]
  ds_read_b128 a[40:43], v18 offset:0
  v_mfma_f32_16x16x32_bf16 v[132:135], a[60:63], a[4:7], v[132:135]
  v_mfma_f32_16x16x32_bf16 v[136:139], a[60:63], a[8:11], v[136:139]
  v_mfma_f32_16x16x32_bf16 v[140:143], a[60:63], a[12:15], v[140:143]
  s_waitcnt lgkmcnt(2)
  v_mfma_f32_16x16x32_bf16 v[144:147], a[32:35], a[0:3], v[144:147]
  ds_read_b128 a[44:47], v13 offset:0
  v_mfma_f32_16x16x32_bf16 v[148:151], a[32:35], a[4:7], v[148:151]
  v_mfma_f32_16x16x32_bf16 v[152:155], a[32:35], a[8:11], v[152:155]
  v_mfma_f32_16x16x32_bf16 v[156:159], a[32:35], a[12:15], v[156:159]
  s_waitcnt lgkmcnt(2)
  v_mfma_f32_16x16x32_bf16 v[160:163], a[36:39], a[0:3], v[160:163]
  ds_read_b128 a[48:51], v13 offset:4096
  v_mfma_f32_16x16x32_bf16 v[164:167], a[36:39], a[4:7], v[164:167]
  v_mfma_f32_16x16x32_bf16 v[168:171], a[36:39], a[8:11], v[168:171]
  v_mfma_f32_16x16x32_bf16 v[172:175], a[36:39], a[12:15], v[172:175]
  s_waitcnt lgkmcnt(2)
  v_mfma_f32_16x16x32_bf16 v[176:179], a[40:43], a[0:3], v[176:179]
  ds_read_b128 a[52:55], v13 offset:8192
  v_mfma_f32_16x16x32_bf16 v[180:183], a[40:43], a[4:7], v[180:183]
  v_mfma_f32_16x16x32_bf16 v[184:187], a[40:43], a[8:11], v[184:187]
  v_mfma_f32_16x16x32_bf16 v[188:191], a[40:43], a[12:15], v[188:191]
  s_waitcnt lgkmcnt(2)
  v_mfma_f32_16x16x32_bf16 v[32:35], a[44:47], a[16:19], v[32:35]
  ds_read_b128 a[56:59], v13 offset:12288
  v_mfma_f32_16x16x32_bf16 v[36:39], a[44:47], a[20:23], v[36:39]
  v_mfma_f32_16x16x32_bf16 v[40:43], a[44:47], a[24:27], v[40:43]
  v_mfma_f32_16x16x32_bf16 v[44:47], a[44:47], a[28:31], v[44:47]
  s_waitcnt lgkmcnt(2)
  v_mfma_f32_16x16x32_bf16 v[48:51], a[48:51], a[16:19], v[48:51]
  ds_read_b128 a[60:63], v13 offset:16384
  v_mfma_f32_16x16x32_bf16 v[52:55], a[48:51], a[20:23], v[52:55]
  v_mfma_f32_16x16x32_bf16 v[56:59], a[48:51], a[24:27], v[56:59]
  v_mfma_f32_16x16x32_bf16 v[60:63], a[48:51], a[28:31], v[60:63]
  s_waitcnt lgkmcnt(2)
  v_mfma_f32_16x16x32_bf16 v[64:67], a[52:55], a[16:19], v[64:67]
  ds_read_b128 a[32:35], v13 offset:20480
  v_mfma_f32_16x16x32_bf16 v[68:71], a[52:55], a[20:23], v[68:71]
  v_mfma_f32_16x16x32_bf16 v[72:75], a[52:55], a[24:27], v[72:75]
  v_mfma_f32_16x16x32_bf16 v[76:79], a[52:55], a[28:31], v[76:79]
  s_waitcnt lgkmcnt(2)
  v_mfma_f32_16x16x32_bf16 v[80:83], a[56:59], a[16:19], v[80:83]
  ds_read_b128 a[36:39], v13 offset:24576
  v_mfma_f32_16x16x32_bf16 v[84:87], a[56:59], a[20:23], v[84:87]
  v_mfma_f32_16x16x32_bf16 v[88:91], a[56:59], a[24:27], v[88:91]
  v_mfma_f32_16x16x32_bf16 v[92:95], a[56:59], a[28:31], v[92:95]
  s_waitcnt lgkmcnt(2)
  v_mfma_f32_16x16x32_bf16 v[96:99], a[60:63], a[16:19], v[96:99]
  ds_read_b128 a[40:43], v13 offset:28672
  ds_read_b128 a[44:47], v13 offset:32768
  v_mfma_f32_16x16x32_bf16 v[100:103], a[60:63], a[20:23], v[100:103]
  v_mfma_f32_16x16x32_bf16 v[104:107], a[60:63], a[24:27], v[104:107]
  v_mfma_f32_16x16x32_bf16 v[108:111], a[60:63], a[28:31], v[108:111]
  s_waitcnt lgkmcnt(3)
  v_mfma_f32_16x16x32_bf16 v[112:115], a[32:35], a[16:19], v[112:115]
  v_mfma_f32_16x16x32_bf16 v[116:119], a[32:35], a[20:23], v[116:119]
  v_mfma_f32_16x16x32_bf16 v[120:123], a[32:35], a[24:27], v[120:123]
  s_waitcnt lgkmcnt(0)
  s_barrier
  ds_read_b128 a[0:3], v7 offset:0
  v_mfma_f32_16x16x32_bf16 v[124:127], a[32:35], a[28:31], v[124:127]
  ds_read_b128 a[4:7], v7 offset:1024
  ds_read_b128 a[8:11], v7 offset:2048
  v_mfma_f32_16x16x32_bf16 v[128:131], a[36:39], a[16:19], v[128:131]
  ds_read_b128 a[12:15], v7 offset:3072
  ds_read_b128 a[48:51], v14 offset:0
  v_mfma_f32_16x16x32_bf16 v[132:135], a[36:39], a[20:23], v[132:135]
  v_mfma_f32_16x16x32_bf16 v[136:139], a[36:39], a[24:27], v[136:139]
  v_mfma_f32_16x16x32_bf16 v[140:143], a[36:39], a[28:31], v[140:143]
  v_mfma_f32_16x16x32_bf16 v[144:147], a[40:43], a[16:19], v[144:147]
  ds_read_b128 a[52:55], v14 offset:4096
  v_mfma_f32_16x16x32_bf16 v[148:151], a[40:43], a[20:23], v[148:151]
  v_mfma_f32_16x16x32_bf16 v[152:155], a[40:43], a[24:27], v[152:155]
  v_mfma_f32_16x16x32_bf16 v[156:159], a[40:43], a[28:31], v[156:159]
  v_mfma_f32_16x16x32_bf16 v[160:163], a[44:47], a[16:19], v[160:163]
  ds_read_b128 a[56:59], v14 offset:8192
  ds_read_b128 a[16:19], v8 offset:0
  v_mfma_f32_16x16x32_bf16 v[164:167], a[44:47], a[20:23], v[164:167]
  ds_read_b128 a[20:23], v8 offset:1024
  v_mfma_f32_16x16x32_bf16 v[168:171], a[44:47], a[24:27], v[168:171]
  ds_read_b128 a[24:27], v8 offset:2048
  v_mfma_f32_16x16x32_bf16 v[172:175], a[44:47], a[28:31], v[172:175]
  s_waitcnt lgkmcnt(5)
  ds_read_b128 a[28:31], v8 offset:3072
  v_mfma_f32_16x16x32_bf16 v[32:35], a[48:51], a[0:3], v[32:35]
  ds_read_b128 a[60:63], v14 offset:12288
L_w1a:
  s_cbranch_execz L_wret1a
  v_mfma_f32_16x16x32_bf16 v[36:39], a[48:51], a[4:7], v[36:39]
  v_mfma_f32_16x16x32_bf16 v[40:43], a[48:51], a[8:11], v[40:43]
  v_mfma_f32_16x16x32_bf16 v[44:47], a[48:51], a[12:15], v[44:47]
  s_waitcnt lgkmcnt(6)
  v_mfma_f32_16x16x32_bf16 v[48:51], a[52:55], a[0:3], v[48:51]
  ds_read_b128 a[32:35], v14 offset:16384
  v_mfma_f32_16x16x32_bf16 v[52:55], a[52:55], a[4:7], v[52:55]
  v_mfma_f32_16x16x32_bf16 v[56:59], a[52:55], a[8:11], v[56:59]
  v_mfma_f32_16x16x32_bf16 v[60:63], a[52:55], a[12:15], v[60:63]
  s_waitcnt lgkmcnt(6)
  v_mfma_f32_16x16x32_bf16 v[64:67], a[56:59], a[0:3], v[64:67]
  ds_read_b128 a[36:39], v14 offset:20480
  v_mfma_f32_16x16x32_bf16 v[68:71], a[56:59], a[4:7], v[68:71]
  v_mfma_f32_16x16x32_bf16 v[72:75], a[56:59], a[8:11], v[72:75]
  v_mfma_f32_16x16x32_bf16 v[76:79], a[56:59], a[12:15], v[76:79]
  s_waitcnt lgkmcnt(2)
  v_mfma_f32_16x16x32_bf16 v[80:83], a[60:63], a[0:3], v[80:83]
  ds_read_b128 a[40:43], v14 offset:24576
  v_mfma_f32_16x16x32_bf16 v[84:87], a[60:63], a[4:7], v[84:87]
  v_mfma_f32_16x16x32_bf16 v[88:91], a[60:63], a[8:11], v[88:91]
  v_mfma_f32_16x16x32_bf16 v[92:95], a[60:63], a[12:15], v[92:95]
  s_waitcnt lgkmcnt(2)
  v_mfma_f32_16x16x32_bf16 v[96:99], a[32:35], a[0:3], v[96:99]
  ds_read_b128 a[44:47], v14 offset:28672
  v_mfma_f32_16x16x32_bf16 v[100:103], a[32:35], a[4:7], v[100:103]
  v_mfma_f32_16x16x32_bf16 v[104:107], a[32:35], a[8:11], v[104:107]
  v_mfma_f32_16x16x32_bf16 v[108:111], a[32:35], a[12:15], v[108:111]
  s_waitcnt lgkmcnt(2)
  v_mfma_f32_16x16x32_bf16 v[112:115], a[36:39], a[0:3], v[112:115]
  ds_read_b128 a[48:51], v14 offset:32768
  v_mfma_f32_16x16x32_bf16 v[116:119], a[36:39], a[4:7], v[116:119]
  v_mfma_f32_16x16x32_bf16 v[120:123], a[36:39], a[8:11], v[120:123]
  v_mfma_f32_16x16x32_bf16 v[124:127], a[36:39], a[12:15], v[124:127]
  s_waitcnt lgkmcnt(2)
  v_mfma_f32_16x16x32_bf16 v[128:131], a[40:43], a[0:3], v[128:131]
  ds_read_b128 a[52:55], v18 offset:38912
  v_mfma_f32_16x16x32_bf16 v[132:135], a[40:43], a[4:7], v[132:135]
  v_mfma_f32_16x16x32_bf16 v[136:139], a[40:43], a[8:11], v[136:139]
  v_mfma_f32_16x16x32_bf16 v[140:143], a[40:43], a[12:15], v[140:143]
  s_waitcnt lgkmcnt(2)
  v_mfma_f32_16x16x32_bf16 v[144:147], a[44:47], a[0:3], v[144:147]
  ds_read_b128 a[56:59], v15 offset:0
  v_mfma_f32_16x16x32_bf16 v[148:151], a[44:47], a[4:7], v[148:151]
  v_mfma_f32_16x16x32_bf16 v[152:155], a[44:47], a[8:11], v[152:155]
  v_mfma_f32_16x16x32_bf16 v[156:159], a[44:47], a[12:15], v[156:159]
  s_waitcnt lgkmcnt(2)
  v_mfma_f32_16x16x32_bf16 v[160:163], a[48:51], a[0:3], v[160:163]
  ds_read_b128 a[60:63], v15 offset:4096
  v_mfma_f32_16x16x32_bf16 v[164:167], a[48:51], a[4:7], v[164:167]
  v_mfma_f32_16x16x32_bf16 v[168:171], a[48:51], a[8:11], v[168:171]
  v_mfma_f32_16x16x32_bf16 v[172:175], a[48:51], a[12:15], v[172:175]
  s_waitcnt lgkmcnt(2)
  v_mfma_f32_16x16x32_bf16 v[176:179], a[52:55], a[0:3], v[176:179]
  ds_read_b128 a[32:35], v15 offset:8192
  v_mfma_f32_16x16x32_bf16 v[180:183], a[52:55], a[4:7], v[180:183]
  v_mfma_f32_16x16x32_bf16 v[184:187], a[52:55], a[8:11], v[184:187]
  v_mfma_f32_16x16x32_bf16 v[188:191], a[52:55], a[12:15], v[188:191]
  s_waitcnt lgkmcnt(2)
  v_mfma_f32_16x16x32_bf16 v[32:35], a[56:59], a[16:19], v[32:35]
  ds_read_b128 a[36:39], v15 offset:12288
  v_mfma_f32_16x16x32_bf16 v[36:39], a[56:59], a[20:23], v[36:39]
  v_mfma_f32_16x16x32_bf16 v[40:43], a[56:59], a[24:27], v[40:43]
  v_mfma_f32_16x16x32_bf16 v[44:47], a[56:59], a[28:31], v[44:47]
  s_waitcnt lgkmcnt(2)
  v_mfma_f32_16x16x32_bf16 v[48:51], a[60:63], a[16:19], v[48:51]
  ds_read_b128 a[40:43], v15 offset:16384
  v_mfma_f32_16x16x32_bf16 v[52:55], a[60:63], a[20:23], v[52:55]
  v_mfma_f32_16x16x32_bf16 v[56:59], a[60:63], a[24:27], v[56:59]
  v_mfma_f32_16x16x32_bf16 v[60:63], a[60:63], a[28:31], v[60:63]
  s_waitcnt lgkmcnt(2)
  v_mfma_f32_16x16x32_bf16 v[64:67], a[32:35], a[16:19], v[64:67]
  ds_read_b128 a[44:47], v15 offset:20480
  v_mfma_f32_16x16x32_bf16 v[68:71], a[32:35], a[20:23], v[68:71]
  v_mfma_f32_16x16x32_bf16 v[72:75], a[32:35], a[24:27], v[72:75]
  v_mfma_f32_16x16x32_bf16 v[76:79], a[32:35], a[28:31], v[76:79]
  s_waitcnt lgkmcnt(2)
  v_mfma_f32_16x16x32_bf16 v[80:83], a[36:39], a[16:19], v[80:83]
  ds_read_b128 a[48:51], v15 offset:24576
  v_mfma_f32_16x16x32_bf16 v[84:87], a[36:39], a[20:23], v[84:87]
  v_mfma_f32_16x16x32_bf16 v[88:91], a[36:39], a[24:27], v[88:91]
  v_mfma_f32_16x16x32_bf16 v[92:95], a[36:39], a[28:31], v[92:95]
  s_waitcnt lgkmcnt(2)
  v_mfma_f32_16x16x32_bf16 v[96:99], a[40:43], a[16:19], v[96:99]
  ds_read_b128 a[52:55], v15 offset:28672
  ds_read_b128 a[56:59], v15 offset:32768
  v_mfma_f32_16x16x32_bf16 v[100:103], a[40:43], a[20:23], v[100:103]
  v_mfma_f32_16x16x32_bf16 v[104:107], a[40:43], a[24:27], v[104:107]
  v_mfma_f32_16x16x32_bf16 v[108:111], a[40:43], a[28:31], v[108:111]
  s_waitcnt lgkmcnt(3)
  v_mfma_f32_16x16x32_bf16 v[112:115], a[44:47], a[16:19], v[112:115]
  v_mfma_f32_16x16x32_bf16 v[116:119], a[44:47], a[20:23], v[116:119]
  v_mfma_f32_16x16x32_bf16 v[120:123], a[44:47], a[24:27], v[120:123]
  s_waitcnt lgkmcnt(0)
  s_barrier
  ds_read_b128 a[0:3], v7 offset:16384
  v_mfma_f32_16x16x32_bf16 v[124:127], a[44:47], a[28:31], v[124:127]
  ds_read_b128 a[4:7], v7 offset:17408
  ds_read_b128 a[8:11], v7 offset:18432
  v_mfma_f32_16x16x32_bf16 v[128:131], a[48:51], a[16:19], v[128:131]
  ds_read_b128 a[12:15], v7 offset:19456
  ds_read_b128 a[60:63], v16 offset:0
  v_mfma_f32_16x16x32_bf16 v[132:135], a[48:51], a[20:23], v[132:135]
  v_mfma_f32_16x16x32_bf16 v[136:139], a[48:51], a[24:27], v[136:139]
  v_mfma_f32_16x16x32_bf16 v[140:143], a[48:51], a[28:31], v[140:143]
  v_mfma_f32_16x16x32_bf16 v[144:147], a[52:55], a[16:19], v[144:147]
  ds_read_b128 a[32:35], v16 offset:4096
  v_mfma_f32_16x16x32_bf16 v[148:151], a[52:55], a[20:23], v[148:151]
  v_mfma_f32_16x16x32_bf16 v[152:155], a[52:55], a[24:27], v[152:155]
  v_mfma_f32_16x16x32_bf16 v[156:159], a[52:55], a[28:31], v[156:159]
  v_mfma_f32_16x16x32_bf16 v[160:163], a[56:59], a[16:19], v[160:163]
  ds_read_b128 a[36:39], v16 offset:8192
  ds_read_b128 a[16:19], v8 offset:16384
  v_mfma_f32_16x16x32_bf16 v[164:167], a[56:59], a[20:23], v[164:167]
  ds_read_b128 a[20:23], v8 offset:17408
  v_mfma_f32_16x16x32_bf16 v[168:171], a[56:59], a[24:27], v[168:171]
  ds_read_b128 a[24:27], v8 offset:18432
  v_mfma_f32_16x16x32_bf16 v[172:175], a[56:59], a[28:31], v[172:175]
  s_waitcnt lgkmcnt(5)
  ds_read_b128 a[28:31], v8 offset:19456
  v_mfma_f32_16x16x32_bf16 v[32:35], a[60:63], a[0:3], v[32:35]
  ds_read_b128 a[40:43], v16 offset:12288
  v_mfma_f32_16x16x32_bf16 v[36:39], a[60:63], a[4:7], v[36:39]
  v_mfma_f32_16x16x32_bf16 v[40:43], a[60:63], a[8:11], v[40:43]
  v_mfma_f32_16x16x32_bf16 v[44:47], a[60:63], a[12:15], v[44:47]
  s_waitcnt lgkmcnt(6)
  v_mfma_f32_16x16x32_bf16 v[48:51], a[32:35], a[0:3], v[48:51]
  ds_read_b128 a[44:47], v16 offset:16384
  v_mfma_f32_16x16x32_bf16 v[52:55], a[32:35], a[4:7], v[52:55]
  v_mfma_f32_16x16x32_bf16 v[56:59], a[32:35], a[8:11], v[56:59]
  v_mfma_f32_16x16x32_bf16 v[60:63], a[32:35], a[12:15], v[60:63]
  s_waitcnt lgkmcnt(6)
  v_mfma_f32_16x16x32_bf16 v[64:67], a[36:39], a[0:3], v[64:67]
  ds_read_b128 a[48:51], v16 offset:20480
  v_mfma_f32_16x16x32_bf16 v[68:71], a[36:39], a[4:7], v[68:71]
  v_mfma_f32_16x16x32_bf16 v[72:75], a[36:39], a[8:11], v[72:75]
  v_mfma_f32_16x16x32_bf16 v[76:79], a[36:39], a[12:15], v[76:79]
  s_waitcnt lgkmcnt(2)
  v_mfma_f32_16x16x32_bf16 v[80:83], a[40:43], a[0:3], v[80:83]
  ds_read_b128 a[52:55], v16 offset:24576
  v_mfma_f32_16x16x32_bf16 v[84:87], a[40:43], a[4:7], v[84:87]
  v_mfma_f32_16x16x32_bf16 v[88:91], a[40:43], a[8:11], v[88:91]
  v_mfma_f32_16x16x32_bf16 v[92:95], a[40:43], a[12:15], v[92:95]
  s_waitcnt lgkmcnt(2)
  v_mfma_f32_16x16x32_bf16 v[96:99], a[44:47], a[0:3], v[96:99]
  ds_read_b128 a[56:59], v16 offset:28672
  v_mfma_f32_16x16x32_bf16 v[100:103], a[44:47], a[4:7], v[100:103]
  v_mfma_f32_16x16x32_bf16 v[104:107], a[44:47], a[8:11], v[104:107]
  v_mfma_f32_16x16x32_bf16 v[108:111], a[44:47], a[12:15], v[108:111]
  s_waitcnt lgkmcnt(2)
  v_mfma_f32_16x16x32_bf16 v[112:115], a[48:51], a[0:3], v[112:115]
  ds_read_b128 a[60:63], v16 offset:32768
  v_mfma_f32_16x16x32_bf16 v[116:119], a[48:51], a[4:7], v[116:119]
  v_mfma_f32_16x16x32_bf16 v[120:123], a[48:51], a[8:11], v[120:123]
  v_mfma_f32_16x16x32_bf16 v[124:127], a[48:51], a[12:15], v[124:127]
  s_waitcnt lgkmcnt(2)
  v_mfma_f32_16x16x32_bf16 v[128:131], a[52:55], a[0:3], v[128:131]
  ds_read_b128 a[32:35], v19 offset:0
  v_mfma_f32_16x16x32_bf16 v[132:135], a[52:55], a[4:7], v[132:135]
  v_mfma_f32_16x16x32_bf16 v[136:139], a[52:55], a[8:11], v[136:139]
  v_mfma_f32_16x16x32_bf16 v[140:143], a[52:55], a[12:15], v[140:143]
  s_waitcnt lgkmcnt(2)
  v_mfma_f32_16x16x32_bf16 v[144:147], a[56:59], a[0:3], v[144:147]
  ds_read_b128 a[36:39], v17 offset:0
  v_mfma_f32_16x16x32_bf16 v[148:151], a[56:59], a[4:7], v[148:151]
  v_mfma_f32_16x16x32_bf16 v[152:155], a[56:59], a[8:11], v[152:155]
  v_mfma_f32_16x16x32_bf16 v[156:159], a[56:59], a[12:15], v[156:159]
  s_waitcnt lgkmcnt(2)
  v_mfma_f32_16x16x32_bf16 v[160:163], a[60:63], a[0:3], v[160:163]
  ds_read_b128 a[40:43], v17 offset:4096
  v_mfma_f32_16x16x32_bf16 v[164:167], a[60:63], a[4:7], v[164:167]
  v_mfma_f32_16x16x32_bf16 v[168:171], a[60:63], a[8:11], v[168:171]
  v_mfma_f32_16x16x32_bf16 v[172:175], a[60:63], a[12:15], v[172:175]
  s_waitcnt lgkmcnt(2)
  v_mfma_f32_16x16x32_bf16 v[176:179], a[32:35], a[0:3], v[176:179]
  ds_read_b128 a[44:47], v17 offset:8192
  v_mfma_f32_16x16x32_bf16 v[180:183], a[32:35], a[4:7], v[180:183]
  v_mfma_f32_16x16x32_bf16 v[184:187], a[32:35], a[8:11], v[184:187]
  v_mfma_f32_16x16x32_bf16 v[188:191], a[32:35], a[12:15], v[188:191]
  s_waitcnt lgkmcnt(2)
  v_mfma_f32_16x16x32_bf16 v[32:35], a[36:39], a[16:19], v[32:35]
  ds_read_b128 a[48:51], v17 offset:12288
  v_mfma_f32_16x16x32_bf16 v[36:39], a[36:39], a[20:23], v[36:39]
  v_mfma_f32_16x16x32_bf16 v[40:43], a[36:39], a[24:27], v[40:43]
  v_mfma_f32_16x16x32_bf16 v[44:47], a[36:39], a[28:31], v[44:47]
  s_waitcnt lgkmcnt(2)
  v_mfma_f32_16x16x32_bf16 v[48:51], a[40:43], a[16:19], v[48:51]
  ds_read_b128 a[52:55], v17 offset:16384
  v_mfma_f32_16x16x32_bf16 v[52:55], a[40:43], a[20:23], v[52:55]
  v_mfma_f32_16x16x32_bf16 v[56:59], a[40:43], a[24:27], v[56:59]
  v_mfma_f32_16x16x32_bf16 v[60:63], a[40:43], a[28:31], v[60:63]
  s_waitcnt lgkmcnt(2)
  v_mfma_f32_16x16x32_bf16 v[64:67], a[44:47], a[16:19], v[64:67]
  ds_read_b128 a[56:59], v17 offset:20480
  v_mfma_f32_16x16x32_bf16 v[68:71], a[44:47], a[20:23], v[68:71]
  v_mfma_f32_16x16x32_bf16 v[72:75], a[44:47], a[24:27], v[72:75]
  v_mfma_f32_16x16x32_bf16 v[76:79], a[44:47], a[28:31], v[76:79]
  s_waitcnt lgkmcnt(2)
  v_mfma_f32_16x16x32_bf16 v[80:83], a[48:51], a[16:19], v[80:83]
  ds_read_b128 a[60:63], v17 offset:24576
  v_mfma_f32_16x16x32_bf16 v[84:87], a[48:51], a[20:23], v[84:87]
  v_mfma_f32_16x16x32_bf16 v[88:91], a[48:51], a[24:27], v[88:91]
  v_mfma_f32_16x16x32_bf16 v[92:95], a[48:51], a[28:31], v[92:95]
  s_waitcnt lgkmcnt(2)
  v_mfma_f32_16x16x32_bf16 v[96:99], a[52:55], a[16:19], v[96:99]
  ds_read_b128 a[32:35], v17 offset:28672
  ds_read_b128 a[36:39], v17 offset:32768
  v_mfma_f32_16x16x32_bf16 v[100:103], a[52:55], a[20:23], v[100:103]
  v_mfma_f32_16x16x32_bf16 v[104:107], a[52:55], a[24:27], v[104:107]
  v_mfma_f32_16x16x32_bf16 v[108:111], a[52:55], a[28:31], v[108:111]
  s_waitcnt lgkmcnt(3)
  v_mfma_f32_16x16x32_bf16 v[112:115], a[56:59], a[16:19], v[112:115]
  v_mfma_f32_16x16x32_bf16 v[116:119], a[56:59], a[20:23], v[116:119]
  v_mfma_f32_16x16x32_bf16 v[120:123], a[56:59], a[24:27], v[120:123]
  s_waitcnt lgkmcnt(0)
  s_barrier
  ds_read_b128 a[0:3], v7 offset:0
  v_mfma_f32_16x16x32_bf16 v[124:127], a[56:59], a[28:31], v[124:127]
  ds_read_b128 a[4:7], v7 offset:1024
  ds_read_b128 a[8:11], v7 offset:2048
  v_mfma_f32_16x16x32_bf16 v[128:131], a[60:63], a[16:19], v[128:131]
  ds_read_b128 a[12:15], v7 offset:3072
  ds_read_b128 a[40:43], v12 offset:0
  v_mfma_f32_16x16x32_bf16 v[132:135], a[60:63], a[20:23], v[132:135]
  v_mfma_f32_16x16x32_bf16 v[136:139], a[60:63], a[24:27], v[136:139]
  v_mfma_f32_16x16x32_bf16 v[140:143], a[60:63], a[28:31], v[140:143]
  v_mfma_f32_16x16x32_bf16 v[144:147], a[32:35], a[16:19], v[144:147]
  ds_read_b128 a[44:47], v12 offset:4096
  v_mfma_f32_16x16x32_bf16 v[148:151], a[32:35], a[20:23], v[148:151]
  v_mfma_f32_16x16x32_bf16 v[152:155], a[32:35], a[24:27], v[152:155]
  v_mfma_f32_16x16x32_bf16 v[156:159], a[32:35], a[28:31], v[156:159]
  v_mfma_f32_16x16x32_bf16 v[160:163], a[36:39], a[16:19], v[160:163]
  ds_read_b128 a[16:19], v8 offset:0
  ds_read_b128 a[48:51], v12 offset:8192
  v_mfma_f32_16x16x32_bf16 v[164:167], a[36:39], a[20:23], v[164:167]
  ds_read_b128 a[20:23], v8 offset:1024
  v_mfma_f32_16x16x32_bf16 v[168:171], a[36:39], a[24:27], v[168:171]
  ds_read_b128 a[24:27], v8 offset:2048
  v_mfma_f32_16x16x32_bf16 v[172:175], a[36:39], a[28:31], v[172:175]
  s_waitcnt lgkmcnt(5)
  ds_read_b128 a[28:31], v8 offset:3072
  v_mfma_f32_16x16x32_bf16 v[32:35], a[40:43], a[0:3], v[32:35]
  ds_read_b128 a[52:55], v12 offset:12288
  v_mfma_f32_16x16x32_bf16 v[36:39], a[40:43], a[4:7], v[36:39]
  v_mfma_f32_16x16x32_bf16 v[40:43], a[40:43], a[8:11], v[40:43]
  v_mfma_f32_16x16x32_bf16 v[44:47], a[40:43], a[12:15], v[44:47]
  s_waitcnt lgkmcnt(6)
  v_mfma_f32_16x16x32_bf16 v[48:51], a[44:47], a[0:3], v[48:51]
  ds_read_b128 a[56:59], v13 offset:0
  v_mfma_f32_16x16x32_bf16 v[52:55], a[44:47], a[4:7], v[52:55]
  v_mfma_f32_16x16x32_bf16 v[56:59], a[44:47], a[8:11], v[56:59]
  v_mfma_f32_16x16x32_bf16 v[60:63], a[44:47], a[12:15], v[60:63]
  s_waitcnt lgkmcnt(5)
  v_mfma_f32_16x16x32_bf16 v[64:67], a[48:51], a[0:3], v[64:67]
  ds_read_b128 a[60:63], v13 offset:4096
  v_mfma_f32_16x16x32_bf16 v[68:71], a[48:51], a[4:7], v[68:71]
  v_mfma_f32_16x16x32_bf16 v[72:75], a[48:51], a[8:11], v[72:75]
  v_mfma_f32_16x16x32_bf16 v[76:79], a[48:51], a[12:15], v[76:79]
  s_waitcnt lgkmcnt(2)
  v_mfma_f32_16x16x32_bf16 v[80:83], a[52:55], a[0:3], v[80:83]
  ds_read_b128 a[32:35], v13 offset:8192
  ds_read_b128 a[36:39], v13 offset:12288
  v_mfma_f32_16x16x32_bf16 v[84:87], a[52:55], a[4:7], v[84:87]
  v_mfma_f32_16x16x32_bf16 v[88:91], a[52:55], a[8:11], v[88:91]
  v_mfma_f32_16x16x32_bf16 v[92:95], a[52:55], a[12:15], v[92:95]
  s_waitcnt lgkmcnt(3)
  v_mfma_f32_16x16x32_bf16 v[32:35], a[56:59], a[16:19], v[32:35]
  v_mfma_f32_16x16x32_bf16 v[36:39], a[56:59], a[20:23], v[36:39]
  v_mfma_f32_16x16x32_bf16 v[40:43], a[56:59], a[24:27], v[40:43]
  s_waitcnt lgkmcnt(0)
  s_barrier
  ds_read_b128 a[0:3], v7 offset:16384
  v_mfma_f32_16x16x32_bf16 v[44:47], a[56:59], a[28:31], v[44:47]
  ds_read_b128 a[4:7], v7 offset:17408
  ds_read_b128 a[8:11], v7 offset:18432
  v_mfma_f32_16x16x32_bf16 v[48:51], a[60:63], a[16:19], v[48:51]
  ds_read_b128 a[12:15], v7 offset:19456
  ds_read_b128 a[40:43], v14 offset:0
  v_mfma_f32_16x16x32_bf16 v[52:55], a[60:63], a[20:23], v[52:55]
  v_mfma_f32_16x16x32_bf16 v[56:59], a[60:63], a[24:27], v[56:59]
  v_mfma_f32_16x16x32_bf16 v[60:63], a[60:63], a[28:31], v[60:63]
  v_mfma_f32_16x16x32_bf16 v[64:67], a[32:35], a[16:19], v[64:67]
  ds_read_b128 a[44:47], v14 offset:4096
  v_mfma_f32_16x16x32_bf16 v[68:71], a[32:35], a[20:23], v[68:71]
  v_mfma_f32_16x16x32_bf16 v[72:75], a[32:35], a[24:27], v[72:75]
  v_mfma_f32_16x16x32_bf16 v[76:79], a[32:35], a[28:31], v[76:79]
  v_mfma_f32_16x16x32_bf16 v[80:83], a[36:39], a[16:19], v[80:83]
  ds_read_b128 a[16:19], v8 offset:16384
  ds_read_b128 a[48:51], v14 offset:8192
  v_mfma_f32_16x16x32_bf16 v[84:87], a[36:39], a[20:23], v[84:87]
  ds_read_b128 a[20:23], v8 offset:17408
  v_mfma_f32_16x16x32_bf16 v[88:91], a[36:39], a[24:27], v[88:91]
  ds_read_b128 a[24:27], v8 offset:18432
  v_mfma_f32_16x16x32_bf16 v[92:95], a[36:39], a[28:31], v[92:95]
  s_waitcnt lgkmcnt(5)
  ds_read_b128 a[28:31], v8 offset:19456
  v_mfma_f32_16x16x32_bf16 v[32:35], a[40:43], a[0:3], v[32:35]
  ds_read_b128 a[52:55], v14 offset:12288
  v_mfma_f32_16x16x32_bf16 v[36:39], a[40:43], a[4:7], v[36:39]
  v_mfma_f32_16x16x32_bf16 v[40:43], a[40:43], a[8:11], v[40:43]
  v_mfma_f32_16x16x32_bf16 v[44:47], a[40:43], a[12:15], v[44:47]
  s_waitcnt lgkmcnt(6)
  v_mfma_f32_16x16x32_bf16 v[48:51], a[44:47], a[0:3], v[48:51]
  ds_read_b128 a[56:59], v15 offset:0
  v_mfma_f32_16x16x32_bf16 v[52:55], a[44:47], a[4:7], v[52:55]
  v_mfma_f32_16x16x32_bf16 v[56:59], a[44:47], a[8:11], v[56:59]
  v_mfma_f32_16x16x32_bf16 v[60:63], a[44:47], a[12:15], v[60:63]
  s_waitcnt lgkmcnt(5)
  v_mfma_f32_16x16x32_bf16 v[64:67], a[48:51], a[0:3], v[64:67]
  ds_read_b128 a[60:63], v15 offset:4096
  v_mfma_f32_16x16x32_bf16 v[68:71], a[48:51], a[4:7], v[68:71]
  v_mfma_f32_16x16x32_bf16 v[72:75], a[48:51], a[8:11], v[72:75]
  v_mfma_f32_16x16x32_bf16 v[76:79], a[48:51], a[12:15], v[76:79]
  s_waitcnt lgkmcnt(2)
  v_mfma_f32_16x16x32_bf16 v[80:83], a[52:55], a[0:3], v[80:83]
  ds_read_b128 a[32:35], v15 offset:8192
  ds_read_b128 a[36:39], v15 offset:12288
  v_mfma_f32_16x16x32_bf16 v[84:87], a[52:55], a[4:7], v[84:87]
  v_mfma_f32_16x16x32_bf16 v[88:91], a[52:55], a[8:11], v[88:91]
  v_mfma_f32_16x16x32_bf16 v[92:95], a[52:55], a[12:15], v[92:95]
  s_waitcnt lgkmcnt(3)
  v_mfma_f32_16x16x32_bf16 v[32:35], a[56:59], a[16:19], v[32:35]
  v_mfma_f32_16x16x32_bf16 v[36:39], a[56:59], a[20:23], v[36:39]
  v_mfma_f32_16x16x32_bf16 v[40:43], a[56:59], a[24:27], v[40:43]
  s_waitcnt lgkmcnt(0)
  s_barrier
  ds_read_b128 a[0:3], v7 offset:37888
  v_mfma_f32_16x16x32_bf16 v[44:47], a[56:59], a[28:31], v[44:47]
  ds_read_b128 a[4:7], v7 offset:38912
  ds_read_b128 a[8:11], v7 offset:39936
  v_mfma_f32_16x16x32_bf16 v[48:51], a[60:63], a[16:19], v[48:51]
  ds_read_b128 a[12:15], v7 offset:40960
  ds_read_b128 a[40:43], v16 offset:0
  v_mfma_f32_16x16x32_bf16 v[52:55], a[60:63], a[20:23], v[52:55]
  v_mfma_f32_16x16x32_bf16 v[56:59], a[60:63], a[24:27], v[56:59]
  v_mfma_f32_16x16x32_bf16 v[60:63], a[60:63], a[28:31], v[60:63]
  v_mfma_f32_16x16x32_bf16 v[64:67], a[32:35], a[16:19], v[64:67]
  ds_read_b128 a[44:47], v16 offset:4096
  v_mfma_f32_16x16x32_bf16 v[68:71], a[32:35], a[20:23], v[68:71]
  v_mfma_f32_16x16x32_bf16 v[72:75], a[32:35], a[24:27], v[72:75]
  v_mfma_f32_16x16x32_bf16 v[76:79], a[32:35], a[28:31], v[76:79]
  v_mfma_f32_16x16x32_bf16 v[80:83], a[36:39], a[16:19], v[80:83]
  ds_read_b128 a[16:19], v8 offset:37888
  ds_read_b128 a[48:51], v16 offset:8192
  v_mfma_f32_16x16x32_bf16 v[84:87], a[36:39], a[20:23], v[84:87]
  ds_read_b128 a[20:23], v8 offset:38912
  v_mfma_f32_16x16x32_bf16 v[88:91], a[36:39], a[24:27], v[88:91]
  ds_read_b128 a[24:27], v8 offset:39936
  v_mfma_f32_16x16x32_bf16 v[92:95], a[36:39], a[28:31], v[92:95]
  s_waitcnt lgkmcnt(5)
  ds_read_b128 a[28:31], v8 offset:40960
  v_mfma_f32_16x16x32_bf16 v[32:35], a[40:43], a[0:3], v[32:35]
  ds_read_b128 a[52:55], v16 offset:12288
  v_mfma_f32_16x16x32_bf16 v[36:39], a[40:43], a[4:7], v[36:39]
  v_mfma_f32_16x16x32_bf16 v[40:43], a[40:43], a[8:11], v[40:43]
  v_mfma_f32_16x16x32_bf16 v[44:47], a[40:43], a[12:15], v[44:47]
  s_waitcnt lgkmcnt(6)
  v_mfma_f32_16x16x32_bf16 v[48:51], a[44:47], a[0:3], v[48:51]
  ds_read_b128 a[56:59], v17 offset:0
  v_mfma_f32_16x16x32_bf16 v[52:55], a[44:47], a[4:7], v[52:55]
  v_mfma_f32_16x16x32_bf16 v[56:59], a[44:47], a[8:11], v[56:59]
  v_mfma_f32_16x16x32_bf16 v[60:63], a[44:47], a[12:15], v[60:63]
  s_waitcnt lgkmcnt(5)
  v_mfma_f32_16x16x32_bf16 v[64:67], a[48:51], a[0:3], v[64:67]
  ds_read_b128 a[60:63], v17 offset:4096
  v_mfma_f32_16x16x32_bf16 v[68:71], a[48:51], a[4:7], v[68:71]
  v_mfma_f32_16x16x32_bf16 v[72:75], a[48:51], a[8:11], v[72:75]
  v_mfma_f32_16x16x32_bf16 v[76:79], a[48:51], a[12:15], v[76:79]
  s_waitcnt lgkmcnt(2)
  v_mfma_f32_16x16x32_bf16 v[80:83], a[52:55], a[0:3], v[80:83]
  ds_read_b128 a[0:3], v7 offset:0
  ds_read_b128 a[32:35], v17 offset:8192
  v_mfma_f32_16x16x32_bf16 v[84:87], a[52:55], a[4:7], v[84:87]
  ds_read_b128 a[4:7], v7 offset:1024
  v_mfma_f32_16x16x32_bf16 v[88:91], a[52:55], a[8:11], v[88:91]
  ds_read_b128 a[8:11], v7 offset:2048
  v_mfma_f32_16x16x32_bf16 v[92:95], a[52:55], a[12:15], v[92:95]
  s_waitcnt lgkmcnt(5)
  ds_read_b128 a[12:15], v7 offset:3072
  v_mfma_f32_16x16x32_bf16 v[32:35], a[56:59], a[16:19], v[32:35]
  ds_read_b128 a[36:39], v17 offset:12288
  v_mfma_f32_16x16x32_bf16 v[36:39], a[56:59], a[20:23], v[36:39]
  v_mfma_f32_16x16x32_bf16 v[40:43], a[56:59], a[24:27], v[40:43]
  s_barrier
  v_mfma_f32_16x16x32_bf16 v[44:47], a[56:59], a[28:31], v[44:47]
  s_waitcnt lgkmcnt(6)
  v_mfma_f32_16x16x32_bf16 v[48:51], a[60:63], a[16:19], v[48:51]
  ds_read_b128 a[40:43], v18 offset:0
  v_mfma_f32_16x16x32_bf16 v[52:55], a[60:63], a[20:23], v[52:55]
  v_mfma_f32_16x16x32_bf16 v[56:59], a[60:63], a[24:27], v[56:59]
  s_mov_b32 s6, 0
  v_mfma_f32_16x16x32_bf16 v[60:63], a[60:63], a[28:31], v[60:63]
  s_waitcnt lgkmcnt(5)
  v_cvt_pk_bf16_f32 v24, v32, v36
  v_cvt_pk_bf16_f32 v25, v40, v44
  v_mfma_f32_16x16x32_bf16 v[64:67], a[32:35], a[16:19], v[64:67]
  ds_read_b128 a[44:47], v12 offset:16384
  buffer_store_dwordx2 v[24:25], v4, s[36:39], s6 offen nt
  v_mfma_f32_16x16x32_bf16 v[68:71], a[32:35], a[20:23], v[68:71]
  v_cvt_pk_bf16_f32 v26, v33, v37
  v_cvt_pk_bf16_f32 v27, v41, v45
  v_mfma_f32_16x16x32_bf16 v[72:75], a[32:35], a[24:27], v[72:75]
  v_mfma_f32_16x16x32_bf16 v[76:79], a[32:35], a[28:31], v[76:79]
  s_waitcnt lgkmcnt(2)
  v_mfma_f32_16x16x32_bf16 v[80:83], a[36:39], a[16:19], v[80:83]
  ds_read_b128 a[16:19], v8 offset:0
  ds_read_b128 a[48:51], v12 offset:20480
  s_mov_b32 s6, 9216
  v_mfma_f32_16x16x32_bf16 v[84:87], a[36:39], a[20:23], v[84:87]
  ds_read_b128 a[20:23], v8 offset:1024
  buffer_store_dwordx2 v[26:27], v4, s[36:39], s6 offen nt
  v_mfma_f32_16x16x32_bf16 v[88:91], a[36:39], a[24:27], v[88:91]
  ds_read_b128 a[24:27], v8 offset:2048
  v_cvt_pk_bf16_f32 v28, v34, v38
  v_mfma_f32_16x16x32_bf16 v[92:95], a[36:39], a[28:31], v[92:95]
  s_waitcnt lgkmcnt(5)
  ds_read_b128 a[28:31], v8 offset:3072
  v_cvt_pk_bf16_f32 v29, v42, v46
  v_mfma_f32_16x16x32_bf16 v[176:179], a[40:43], a[0:3], v[176:179]
  ds_read_b128 a[52:55], v12 offset:24576
  s_mov_b32 s6, 18432
  v_mfma_f32_16x16x32_bf16 v[180:183], a[40:43], a[4:7], v[180:183]
  buffer_store_dwordx2 v[28:29], v4, s[36:39], s6 offen nt
  v_cvt_pk_bf16_f32 v30, v35, v39
  v_mfma_f32_16x16x32_bf16 v[184:187], a[40:43], a[8:11], v[184:187]
  v_cvt_pk_bf16_f32 v31, v43, v47
  v_mfma_f32_16x16x32_bf16 v[188:191], a[40:43], a[12:15], v[188:191]
  s_waitcnt lgkmcnt(6)
  v_mfma_f32_16x16x32_bf16 v[96:99], a[44:47], a[0:3], v[96:99]
  ds_read_b128 a[56:59], v13 offset:16384
  s_mov_b32 s6, 27648
  v_mfma_f32_16x16x32_bf16 v[100:103], a[44:47], a[4:7], v[100:103]
  buffer_store_dwordx2 v[30:31], v4, s[36:39], s6 offen nt
  v_cvt_pk_bf16_f32 v20, v48, v52
  v_mfma_f32_16x16x32_bf16 v[104:107], a[44:47], a[8:11], v[104:107]
  v_cvt_pk_bf16_f32 v21, v56, v60
  v_mfma_f32_16x16x32_bf16 v[108:111], a[44:47], a[12:15], v[108:111]
  s_waitcnt lgkmcnt(5)
  v_mfma_f32_16x16x32_bf16 v[112:115], a[48:51], a[0:3], v[112:115]
  ds_read_b128 a[60:63], v13 offset:20480
  s_mov_b32 s6, 294912
  v_mfma_f32_16x16x32_bf16 v[116:119], a[48:51], a[4:7], v[116:119]
  buffer_store_dwordx2 v[20:21], v4, s[36:39], s6 offen nt
  v_cvt_pk_bf16_f32 v22, v49, v53
  v_mfma_f32_16x16x32_bf16 v[120:123], a[48:51], a[8:11], v[120:123]
  v_cvt_pk_bf16_f32 v23, v57, v61
  v_mfma_f32_16x16x32_bf16 v[124:127], a[48:51], a[12:15], v[124:127]
  s_waitcnt lgkmcnt(2)
  v_mfma_f32_16x16x32_bf16 v[128:131], a[52:55], a[0:3], v[128:131]
  ds_read_b128 a[0:3], v7 offset:16384
  ds_read_b128 a[32:35], v13 offset:24576
  s_mov_b32 s6, 304128
  v_mfma_f32_16x16x32_bf16 v[132:135], a[52:55], a[4:7], v[132:135]
  ds_read_b128 a[4:7], v7 offset:17408
  buffer_store_dwordx2 v[22:23], v4, s[36:39], s6 offen nt
  v_mfma_f32_16x16x32_bf16 v[136:139], a[52:55], a[8:11], v[136:139]
  s_barrier
  ds_read_b128 a[8:11], v7 offset:18432
  v_mfma_f32_16x16x32_bf16 v[140:143], a[52:55], a[12:15], v[140:143]
  s_waitcnt lgkmcnt(5)
  ds_read_b128 a[12:15], v7 offset:19456
  v_cvt_pk_bf16_f32 v24, v50, v54
  v_mfma_f32_16x16x32_bf16 v[96:99], a[56:59], a[16:19], v[96:99]
  ds_read_b128 a[36:39], v18 offset:38912
  v_cvt_pk_bf16_f32 v25, v58, v62
  s_mov_b32 s6, 313344
  v_mfma_f32_16x16x32_bf16 v[100:103], a[56:59], a[20:23], v[100:103]
  buffer_store_dwordx2 v[24:25], v4, s[36:39], s6 offen nt
  v_cvt_pk_bf16_f32 v26, v51, v55
  v_mfma_f32_16x16x32_bf16 v[104:107], a[56:59], a[24:27], v[104:107]
  v_cvt_pk_bf16_f32 v27, v59, v63
  v_mfma_f32_16x16x32_bf16 v[108:111], a[56:59], a[28:31], v[108:111]
  s_waitcnt lgkmcnt(6)
  v_mfma_f32_16x16x32_bf16 v[112:115], a[60:63], a[16:19], v[112:115]
  ds_read_b128 a[40:43], v14 offset:16384
  s_mov_b32 s6, 322560
  v_mfma_f32_16x16x32_bf16 v[116:119], a[60:63], a[20:23], v[116:119]
  buffer_store_dwordx2 v[26:27], v4, s[36:39], s6 offen nt
  v_cvt_pk_bf16_f32 v28, v64, v68
  v_mfma_f32_16x16x32_bf16 v[120:123], a[60:63], a[24:27], v[120:123]
  v_cvt_pk_bf16_f32 v29, v72, v76
  v_mfma_f32_16x16x32_bf16 v[124:127], a[60:63], a[28:31], v[124:127]
  s_waitcnt lgkmcnt(5)
  v_mfma_f32_16x16x32_bf16 v[128:131], a[32:35], a[16:19], v[128:131]
  ds_read_b128 a[16:19], v8 offset:16384
  ds_read_b128 a[44:47], v14 offset:20480
  s_mov_b32 s6, 589824
  v_mfma_f32_16x16x32_bf16 v[132:135], a[32:35], a[20:23], v[132:135]
  ds_read_b128 a[20:23], v8 offset:17408
  buffer_store_dwordx2 v[28:29], v4, s[36:39], s6 offen nt
  v_mfma_f32_16x16x32_bf16 v[136:139], a[32:35], a[24:27], v[136:139]
  ds_read_b128 a[24:27], v8 offset:18432
  v_cvt_pk_bf16_f32 v30, v65, v69
  v_mfma_f32_16x16x32_bf16 v[140:143], a[32:35], a[28:31], v[140:143]
  s_waitcnt lgkmcnt(5)
  ds_read_b128 a[28:31], v8 offset:19456
  v_cvt_pk_bf16_f32 v31, v73, v77
  v_mfma_f32_16x16x32_bf16 v[176:179], a[36:39], a[0:3], v[176:179]
  ds_read_b128 a[48:51], v14 offset:24576
  s_mov_b32 s6, 599040
  v_mfma_f32_16x16x32_bf16 v[180:183], a[36:39], a[4:7], v[180:183]
  buffer_store_dwordx2 v[30:31], v4, s[36:39], s6 offen nt
  v_cvt_pk_bf16_f32 v20, v66, v70
  v_mfma_f32_16x16x32_bf16 v[184:187], a[36:39], a[8:11], v[184:187]
  v_cvt_pk_bf16_f32 v21, v74, v78
  v_mfma_f32_16x16x32_bf16 v[188:191], a[36:39], a[12:15], v[188:191]
  s_waitcnt lgkmcnt(6)
  v_mfma_f32_16x16x32_bf16 v[96:99], a[40:43], a[0:3], v[96:99]
  ds_read_b128 a[52:55], v15 offset:16384
  s_mov_b32 s6, 608256
  v_mfma_f32_16x16x32_bf16 v[100:103], a[40:43], a[4:7], v[100:103]
  buffer_store_dwordx2 v[20:21], v4, s[36:39], s6 offen nt
  v_cvt_pk_bf16_f32 v22, v67, v71
  v_mfma_f32_16x16x32_bf16 v[104:107], a[40:43], a[8:11], v[104:107]
  v_cvt_pk_bf16_f32 v23, v75, v79
  v_mfma_f32_16x16x32_bf16 v[108:111], a[40:43], a[12:15], v[108:111]
  s_waitcnt lgkmcnt(5)
  v_mfma_f32_16x16x32_bf16 v[112:115], a[44:47], a[0:3], v[112:115]
  ds_read_b128 a[56:59], v15 offset:20480
  s_mov_b32 s6, 617472
  v_mfma_f32_16x16x32_bf16 v[116:119], a[44:47], a[4:7], v[116:119]
  buffer_store_dwordx2 v[22:23], v4, s[36:39], s6 offen nt
  v_cvt_pk_bf16_f32 v24, v80, v84
  v_mfma_f32_16x16x32_bf16 v[120:123], a[44:47], a[8:11], v[120:123]
  v_cvt_pk_bf16_f32 v25, v88, v92
  v_mfma_f32_16x16x32_bf16 v[124:127], a[44:47], a[12:15], v[124:127]
  s_waitcnt lgkmcnt(2)
  v_mfma_f32_16x16x32_bf16 v[128:131], a[48:51], a[0:3], v[128:131]
  ds_read_b128 a[0:3], v7 offset:37888
  ds_read_b128 a[60:63], v15 offset:24576
  s_mov_b32 s6, 884736
  v_mfma_f32_16x16x32_bf16 v[132:135], a[48:51], a[4:7], v[132:135]
  ds_read_b128 a[4:7], v7 offset:38912
  buffer_store_dwordx2 v[24:25], v4, s[36:39], s6 offen nt
  v_mfma_f32_16x16x32_bf16 v[136:139], a[48:51], a[8:11], v[136:139]
  s_barrier
  ds_read_b128 a[8:11], v7 offset:39936
  v_mfma_f32_16x16x32_bf16 v[140:143], a[48:51], a[12:15], v[140:143]
  s_waitcnt lgkmcnt(5)
  ds_read_b128 a[12:15], v7 offset:40960
  v_cvt_pk_bf16_f32 v26, v81, v85
  v_mfma_f32_16x16x32_bf16 v[96:99], a[52:55], a[16:19], v[96:99]
  ds_read_b128 a[32:35], v19 offset:0
  v_cvt_pk_bf16_f32 v27, v89, v93
  s_mov_b32 s6, 893952
  v_mfma_f32_16x16x32_bf16 v[100:103], a[52:55], a[20:23], v[100:103]
  buffer_store_dwordx2 v[26:27], v4, s[36:39], s6 offen nt
  v_cvt_pk_bf16_f32 v28, v82, v86
  v_mfma_f32_16x16x32_bf16 v[104:107], a[52:55], a[24:27], v[104:107]
L_w2a:
  s_cbranch_execz L_wret1a
  v_cvt_pk_bf16_f32 v29, v90, v94
  v_mfma_f32_16x16x32_bf16 v[108:111], a[52:55], a[28:31], v[108:111]
  s_waitcnt lgkmcnt(6)
  v_mfma_f32_16x16x32_bf16 v[112:115], a[56:59], a[16:19], v[112:115]
  ds_read_b128 a[36:39], v16 offset:16384
  s_mov_b32 s6, 903168
  v_mfma_f32_16x16x32_bf16 v[116:119], a[56:59], a[20:23], v[116:119]
  buffer_store_dwordx2 v[28:29], v4, s[36:39], s6 offen nt
  v_cvt_pk_bf16_f32 v30, v83, v87
  v_mfma_f32_16x16x32_bf16 v[120:123], a[56:59], a[24:27], v[120:123]
  v_cvt_pk_bf16_f32 v31, v91, v95
  v_mfma_f32_16x16x32_bf16 v[124:127], a[56:59], a[28:31], v[124:127]
  s_waitcnt lgkmcnt(5)
  v_mfma_f32_16x16x32_bf16 v[128:131], a[60:63], a[16:19], v[128:131]
  ds_read_b128 a[16:19], v8 offset:37888
  ds_read_b128 a[40:43], v16 offset:20480
  s_mov_b32 s6, 912384
  v_mfma_f32_16x16x32_bf16 v[132:135], a[60:63], a[20:23], v[132:135]
  ds_read_b128 a[20:23], v8 offset:38912
  buffer_store_dwordx2 v[30:31], v4, s[36:39], s6 offen nt
  v_mfma_f32_16x16x32_bf16 v[136:139], a[60:63], a[24:27], v[136:139]
  ds_read_b128 a[24:27], v8 offset:39936
  v_mfma_f32_16x16x32_bf16 v[140:143], a[60:63], a[28:31], v[140:143]
  s_waitcnt lgkmcnt(5)
  ds_read_b128 a[28:31], v8 offset:40960
  v_mfma_f32_16x16x32_bf16 v[176:179], a[32:35], a[0:3], v[176:179]
  ds_read_b128 a[44:47], v16 offset:24576
  v_mfma_f32_16x16x32_bf16 v[180:183], a[32:35], a[4:7], v[180:183]
  v_mfma_f32_16x16x32_bf16 v[184:187], a[32:35], a[8:11], v[184:187]
  v_mfma_f32_16x16x32_bf16 v[188:191], a[32:35], a[12:15], v[188:191]
  s_waitcnt lgkmcnt(6)
  v_mfma_f32_16x16x32_bf16 v[96:99], a[36:39], a[0:3], v[96:99]
  ds_read_b128 a[48:51], v17 offset:16384
  v_mfma_f32_16x16x32_bf16 v[100:103], a[36:39], a[4:7], v[100:103]
  v_mfma_f32_16x16x32_bf16 v[104:107], a[36:39], a[8:11], v[104:107]
  v_mfma_f32_16x16x32_bf16 v[108:111], a[36:39], a[12:15], v[108:111]
  s_waitcnt lgkmcnt(5)
  ds_write_b128 v10, v[176:179] offset:0
  v_mfma_f32_16x16x32_bf16 v[112:115], a[40:43], a[0:3], v[112:115]
  ds_read_b128 a[52:55], v17 offset:20480
  ds_write_b128 v10, v[180:183] offset:1024
  v_mfma_f32_16x16x32_bf16 v[116:119], a[40:43], a[4:7], v[116:119]
  ds_write_b128 v10, v[184:187] offset:2048
  v_mfma_f32_16x16x32_bf16 v[120:123], a[40:43], a[8:11], v[120:123]
  ds_write_b128 v10, v[188:191] offset:3072
  v_mfma_f32_16x16x32_bf16 v[124:127], a[40:43], a[12:15], v[124:127]
  s_waitcnt lgkmcnt(6)
  v_mfma_f32_16x16x32_bf16 v[128:131], a[44:47], a[0:3], v[128:131]
  ds_read_b128 a[0:3], v7 offset:0
  ds_read_b128 a[56:59], v17 offset:24576
  v_mfma_f32_16x16x32_bf16 v[132:135], a[44:47], a[4:7], v[132:135]
  ds_read_b128 a[4:7], v7 offset:1024
  v_mfma_f32_16x16x32_bf16 v[136:139], a[44:47], a[8:11], v[136:139]
  s_waitcnt lgkmcnt(3)
  s_barrier
  ds_read_b128 a[8:11], v7 offset:2048
  v_mfma_f32_16x16x32_bf16 v[140:143], a[44:47], a[12:15], v[140:143]
  ds_read_b128 a[12:15], v7 offset:3072
  ds_read2st64_b64 v[176:179], v9 offset0:158 offset1:174
  v_mfma_f32_16x16x32_bf16 v[96:99], a[48:51], a[16:19], v[96:99]
  ds_read_b128 a[60:63], v12 offset:28672
  ds_read2st64_b64 v[180:183], v9 offset0:160 offset1:176
  v_mfma_f32_16x16x32_bf16 v[100:103], a[48:51], a[20:23], v[100:103]
  ds_read2st64_b64 v[184:187], v9 offset0:162 offset1:178
  ds_read2st64_b64 v[188:191], v9 offset0:164 offset1:180
  v_mfma_f32_16x16x32_bf16 v[104:107], a[48:51], a[24:27], v[104:107]
  v_mfma_f32_16x16x32_bf16 v[108:111], a[48:51], a[28:31], v[108:111]
  v_mfma_f32_16x16x32_bf16 v[112:115], a[52:55], a[16:19], v[112:115]
  ds_read_b128 a[32:35], v12 offset:32768
  v_mfma_f32_16x16x32_bf16 v[116:119], a[52:55], a[20:23], v[116:119]
  v_mfma_f32_16x16x32_bf16 v[120:123], a[52:55], a[24:27], v[120:123]
  v_mfma_f32_16x16x32_bf16 v[124:127], a[52:55], a[28:31], v[124:127]
  s_waitcnt lgkmcnt(9)
  v_cvt_pk_bf16_f32 v20, v96, v100
  v_cvt_pk_bf16_f32 v21, v104, v108
  v_mfma_f32_16x16x32_bf16 v[128:131], a[56:59], a[16:19], v[128:131]
  ds_read_b128 a[16:19], v8 offset:0
  ds_read_b128 a[36:39], v13 offset:28672
  s_mov_b32 s6, 1179648
  v_mfma_f32_16x16x32_bf16 v[132:135], a[56:59], a[20:23], v[132:135]
  ds_read_b128 a[20:23], v8 offset:1024
  buffer_store_dwordx2 v[20:21], v4, s[36:39], s6 offen nt
  v_mfma_f32_16x16x32_bf16 v[136:139], a[56:59], a[24:27], v[136:139]
  ds_read_b128 a[24:27], v8 offset:2048
  v_cvt_pk_bf16_f32 v22, v97, v101
  v_mfma_f32_16x16x32_bf16 v[140:143], a[56:59], a[28:31], v[140:143]
  s_waitcnt lgkmcnt(8)
  ds_read_b128 a[28:31], v8 offset:3072
  v_cvt_pk_bf16_f32 v23, v105, v109
  v_mfma_f32_16x16x32_bf16 v[144:147], a[60:63], a[0:3], v[144:147]
  ds_read_b128 a[40:43], v13 offset:32768
  s_mov_b32 s6, 1188864
  v_mfma_f32_16x16x32_bf16 v[148:151], a[60:63], a[4:7], v[148:151]
  buffer_store_dwordx2 v[22:23], v4, s[36:39], s6 offen nt
  v_cvt_pk_bf16_f32 v24, v98, v102
  v_mfma_f32_16x16x32_bf16 v[152:155], a[60:63], a[8:11], v[152:155]
  v_cvt_pk_bf16_f32 v25, v106, v110
  v_mfma_f32_16x16x32_bf16 v[156:159], a[60:63], a[12:15], v[156:159]
  s_waitcnt lgkmcnt(6)
  v_mfma_f32_16x16x32_bf16 v[160:163], a[32:35], a[0:3], v[160:163]
  ds_read_b128 a[0:3], v7 offset:16384
  ds_read_b128 a[44:47], v14 offset:28672
  s_mov_b32 s6, 1198080
  v_mfma_f32_16x16x32_bf16 v[164:167], a[32:35], a[4:7], v[164:167]
  ds_read_b128 a[4:7], v7 offset:17408
  buffer_store_dwordx2 v[24:25], v4, s[36:39], s6 offen nt
  v_mfma_f32_16x16x32_bf16 v[168:171], a[32:35], a[8:11], v[168:171]
  ds_read_b128 a[8:11], v7 offset:18432
  v_cvt_pk_bf16_f32 v26, v99, v103
  v_mfma_f32_16x16x32_bf16 v[172:175], a[32:35], a[12:15], v[172:175]
  s_waitcnt lgkmcnt(8)
  ds_read_b128 a[12:15], v7 offset:19456
  v_cvt_pk_bf16_f32 v27, v107, v111
  v_mfma_f32_16x16x32_bf16 v[144:147], a[36:39], a[16:19], v[144:147]
  s_waitcnt lgkmcnt(8)
  ds_read_b128 a[48:51], v14 offset:32768
  s_mov_b32 s6, 1207296
  v_mfma_f32_16x16x32_bf16 v[148:151], a[36:39], a[20:23], v[148:151]
  s_waitcnt lgkmcnt(8)
  buffer_store_dwordx2 v[26:27], v4, s[36:39], s6 offen nt
  v_add_f32 v176, v176, v178
  v_mfma_f32_16x16x32_bf16 v[152:155], a[36:39], a[24:27], v[152:155]
  s_waitcnt lgkmcnt(7)
  v_add_f32 v177, v177, v179
  v_add_f32 v180, v180, v182
  v_mfma_f32_16x16x32_bf16 v[156:159], a[36:39], a[28:31], v[156:159]
  s_waitcnt lgkmcnt(6)
  v_add_f32 v181, v181, v183
  v_add_f32 v184, v184, v186
  v_mfma_f32_16x16x32_bf16 v[160:163], a[40:43], a[16:19], v[160:163]
  ds_read_b128 a[16:19], v8 offset:16384
  ds_read_b128 a[52:55], v15 offset:28672
  v_mfma_f32_16x16x32_bf16 v[164:167], a[40:43], a[20:23], v[164:167]
  ds_read_b128 a[20:23], v8 offset:17408
  v_add_f32 v185, v185, v187
  v_mfma_f32_16x16x32_bf16 v[168:171], a[40:43], a[24:27], v[168:171]
  ds_read_b128 a[24:27], v8 offset:18432
  v_add_f32 v188, v188, v190
  v_mfma_f32_16x16x32_bf16 v[172:175], a[40:43], a[28:31], v[172:175]
  s_waitcnt lgkmcnt(8)
  ds_read_b128 a[28:31], v8 offset:19456
  v_add_f32 v189, v189, v191
  v_mfma_f32_16x16x32_bf16 v[144:147], a[44:47], a[0:3], v[144:147]
  s_waitcnt lgkmcnt(8)
  ds_read_b128 a[56:59], v15 offset:32768
  v_cvt_pk_bf16_f32 v20, v176, v180
  s_mov_b32 s6, 0
  v_mfma_f32_16x16x32_bf16 v[148:151], a[44:47], a[4:7], v[148:151]
  s_waitcnt lgkmcnt(8)
  v_cvt_pk_bf16_f32 v21, v184, v188
  buffer_store_dwordx2 v[20:21], v0, s[36:39], s6 offen nt
  v_mfma_f32_16x16x32_bf16 v[152:155], a[44:47], a[8:11], v[152:155]
  s_waitcnt lgkmcnt(7)
  v_cvt_pk_bf16_f32 v22, v177, v181
  v_cvt_pk_bf16_f32 v23, v185, v189
  v_mfma_f32_16x16x32_bf16 v[156:159], a[44:47], a[12:15], v[156:159]
  s_waitcnt lgkmcnt(6)
  v_mfma_f32_16x16x32_bf16 v[160:163], a[48:51], a[0:3], v[160:163]
  ds_read_b128 a[0:3], v7 offset:37888
  ds_read_b128 a[60:63], v16 offset:28672
  s_mov_b32 s6, 9216
  v_mfma_f32_16x16x32_bf16 v[164:167], a[48:51], a[4:7], v[164:167]
  ds_read_b128 a[4:7], v7 offset:38912
  buffer_store_dwordx2 v[22:23], v0, s[36:39], s6 offen nt
  v_mfma_f32_16x16x32_bf16 v[168:171], a[48:51], a[8:11], v[168:171]
  ds_read_b128 a[8:11], v7 offset:39936
  v_cvt_pk_bf16_f32 v28, v112, v116
  v_mfma_f32_16x16x32_bf16 v[172:175], a[48:51], a[12:15], v[172:175]
  s_waitcnt lgkmcnt(8)
  ds_read_b128 a[12:15], v7 offset:40960
  v_cvt_pk_bf16_f32 v29, v120, v124
  v_mfma_f32_16x16x32_bf16 v[144:147], a[52:55], a[16:19], v[144:147]
  s_waitcnt lgkmcnt(8)
  ds_read_b128 a[32:35], v16 offset:32768
  s_mov_b32 s6, 1474560
  v_mfma_f32_16x16x32_bf16 v[148:151], a[52:55], a[20:23], v[148:151]
  s_waitcnt lgkmcnt(8)
  buffer_store_dwordx2 v[28:29], v4, s[36:39], s6 offen nt
  v_cvt_pk_bf16_f32 v30, v113, v117
  v_mfma_f32_16x16x32_bf16 v[152:155], a[52:55], a[24:27], v[152:155]
  s_waitcnt lgkmcnt(7)
  v_cvt_pk_bf16_f32 v31, v121, v125
  v_mfma_f32_16x16x32_bf16 v[156:159], a[52:55], a[28:31], v[156:159]
  s_waitcnt lgkmcnt(6)
  v_mfma_f32_16x16x32_bf16 v[160:163], a[56:59], a[16:19], v[160:163]
  ds_read_b128 a[16:19], v8 offset:37888
  ds_read_b128 a[36:39], v17 offset:28672
  s_mov_b32 s6, 1483776
  v_mfma_f32_16x16x32_bf16 v[164:167], a[56:59], a[20:23], v[164:167]
  ds_read_b128 a[20:23], v8 offset:38912
  buffer_store_dwordx2 v[30:31], v4, s[36:39], s6 offen nt
  v_mfma_f32_16x16x32_bf16 v[168:171], a[56:59], a[24:27], v[168:171]
  ds_read_b128 a[24:27], v8 offset:39936
  v_cvt_pk_bf16_f32 v20, v114, v118
  v_mfma_f32_16x16x32_bf16 v[172:175], a[56:59], a[28:31], v[172:175]
  s_waitcnt lgkmcnt(8)
  ds_read_b128 a[28:31], v8 offset:40960
  v_cvt_pk_bf16_f32 v21, v122, v126
  v_mfma_f32_16x16x32_bf16 v[144:147], a[60:63], a[0:3], v[144:147]
  s_waitcnt lgkmcnt(8)
  ds_read_b128 a[40:43], v17 offset:32768
  s_mov_b32 s6, 1492992
  v_mfma_f32_16x16x32_bf16 v[148:151], a[60:63], a[4:7], v[148:151]
  s_waitcnt lgkmcnt(8)
  buffer_store_dwordx2 v[20:21], v4, s[36:39], s6 offen nt
  v_cvt_pk_bf16_f32 v22, v115, v119
  v_mfma_f32_16x16x32_bf16 v[152:155], a[60:63], a[8:11], v[152:155]
  s_waitcnt lgkmcnt(7)
  v_cvt_pk_bf16_f32 v23, v123, v127
  v_mfma_f32_16x16x32_bf16 v[156:159], a[60:63], a[12:15], v[156:159]
  s_waitcnt lgkmcnt(6)
  v_mfma_f32_16x16x32_bf16 v[160:163], a[32:35], a[0:3], v[160:163]
  s_mov_b32 s6, 1502208
  v_mfma_f32_16x16x32_bf16 v[164:167], a[32:35], a[4:7], v[164:167]
  buffer_store_dwordx2 v[22:23], v4, s[36:39], s6 offen nt
  v_cvt_pk_bf16_f32 v24, v128, v132
  v_mfma_f32_16x16x32_bf16 v[168:171], a[32:35], a[8:11], v[168:171]
  v_cvt_pk_bf16_f32 v25, v136, v140
  v_mfma_f32_16x16x32_bf16 v[172:175], a[32:35], a[12:15], v[172:175]
  s_waitcnt lgkmcnt(4)
  v_mfma_f32_16x16x32_bf16 v[144:147], a[36:39], a[16:19], v[144:147]
  s_waitcnt lgkmcnt(3)
  s_mov_b32 s6, 1769472
  v_mfma_f32_16x16x32_bf16 v[148:151], a[36:39], a[20:23], v[148:151]
  s_waitcnt lgkmcnt(2)
  buffer_store_dwordx2 v[24:25], v4, s[36:39], s6 offen nt
  v_cvt_pk_bf16_f32 v26, v129, v133
  v_mfma_f32_16x16x32_bf16 v[152:155], a[36:39], a[24:27], v[152:155]
  s_waitcnt lgkmcnt(1)
  v_cvt_pk_bf16_f32 v27, v137, v141
  v_mfma_f32_16x16x32_bf16 v[156:159], a[36:39], a[28:31], v[156:159]
  s_waitcnt lgkmcnt(0)
  v_mfma_f32_16x16x32_bf16 v[160:163], a[40:43], a[16:19], v[160:163]
  s_mov_b32 s6, 1778688
  v_mfma_f32_16x16x32_bf16 v[164:167], a[40:43], a[20:23], v[164:167]
  buffer_store_dwordx2 v[26:27], v4, s[36:39], s6 offen nt
  v_cvt_pk_bf16_f32 v28, v130, v134
  v_mfma_f32_16x16x32_bf16 v[168:171], a[40:43], a[24:27], v[168:171]
  s_mov_b32 s6, 1787904
  v_cvt_pk_bf16_f32 v29, v138, v142
  buffer_store_dwordx2 v[28:29], v4, s[36:39], s6 offen nt
  v_mfma_f32_16x16x32_bf16 v[172:175], a[40:43], a[28:31], v[172:175]
  v_cvt_pk_bf16_f32 v30, v131, v135
  v_cvt_pk_bf16_f32 v31, v139, v143
  s_mov_b32 s6, 1797120
  buffer_store_dwordx2 v[30:31], v4, s[36:39], s6 offen nt
  v_cvt_pk_bf16_f32 v20, v144, v148
  v_cvt_pk_bf16_f32 v21, v152, v156
  s_mov_b32 s6, 2064384
  buffer_store_dwordx2 v[20:21], v4, s[36:39], s6 offen nt
  v_cvt_pk_bf16_f32 v22, v145, v149
  v_cvt_pk_bf16_f32 v23, v153, v157
  s_mov_b32 s6, 2073600
  buffer_store_dwordx2 v[22:23], v4, s[36:39], s6 offen nt
  v_cvt_pk_bf16_f32 v24, v146, v150
  v_cvt_pk_bf16_f32 v25, v154, v158
  s_mov_b32 s6, 2082816
  buffer_store_dwordx2 v[24:25], v4, s[36:39], s6 offen nt
  v_cvt_pk_bf16_f32 v26, v147, v151
  v_cvt_pk_bf16_f32 v27, v155, v159
  s_mov_b32 s6, 2092032
  buffer_store_dwordx2 v[26:27], v4, s[36:39], s6 offen nt
  v_cvt_pk_bf16_f32 v28, v160, v164
  v_cvt_pk_bf16_f32 v29, v168, v172
  s_mov_b32 s6, 2359296
  buffer_store_dwordx2 v[28:29], v4, s[36:39], s6 offen nt
  v_cvt_pk_bf16_f32 v30, v161, v165
  v_cvt_pk_bf16_f32 v31, v169, v173
  s_mov_b32 s6, 2368512
  buffer_store_dwordx2 v[30:31], v4, s[36:39], s6 offen nt
  v_cvt_pk_bf16_f32 v20, v162, v166
  v_cvt_pk_bf16_f32 v21, v170, v174
  s_mov_b32 s6, 2377728
  buffer_store_dwordx2 v[20:21], v4, s[36:39], s6 offen nt
  v_cvt_pk_bf16_f32 v22, v163, v167
  v_cvt_pk_bf16_f32 v23, v171, v175
  s_mov_b32 s6, 2386944
  buffer_store_dwordx2 v[22:23], v4, s[36:39], s6 offen nt
  s_endpgm
L_endc1a:
L_beg1b:
  s_mov_b64 exec, 0
  s_cmp_eq_u32 s3, 0
  s_cbranch_scc1 L_w1b
  s_cmp_eq_u32 s3, 1
  s_cbranch_scc1 L_w2b
  s_cmp_eq_u32 s3, 2
  s_cbranch_scc1 L_w3b
  s_branch L_w4b
L_wret1b:
  s_mov_b64 exec, -1
  s_barrier
  ds_read_b128 a[0:3], v7 offset:0
  ds_read_b128 a[4:7], v7 offset:1024
  ds_read_b128 a[8:11], v7 offset:2048
  ds_read_b128 a[12:15], v7 offset:3072
  ds_read_b128 a[32:35], v12 offset:0
  ds_read_b128 a[36:39], v12 offset:4096
  ds_read_b128 a[40:43], v12 offset:8192
  ds_read_b128 a[16:19], v8 offset:0
  ds_read_b128 a[20:23], v8 offset:1024
  ds_read_b128 a[24:27], v8 offset:2048
  ds_read_b128 a[28:31], v8 offset:3072
  s_waitcnt lgkmcnt(6)
  v_mfma_f32_16x16x32_bf16 v[32:35], a[32:35], a[0:3], 0
  ds_read_b128 a[44:47], v12 offset:12288
  v_mfma_f32_16x16x32_bf16 v[36:39], a[32:35], a[4:7], 0
  v_mfma_f32_16x16x32_bf16 v[40:43], a[32:35], a[8:11], 0
  v_mfma_f32_16x16x32_bf16 v[44:47], a[32:35], a[12:15], 0
  s_waitcnt lgkmcnt(6)
  v_mfma_f32_16x16x32_bf16 v[48:51], a[36:39], a[0:3], 0
  ds_read_b128 a[48:51], v12 offset:16384
  v_mfma_f32_16x16x32_bf16 v[52:55], a[36:39], a[4:7], 0
  v_mfma_f32_16x16x32_bf16 v[56:59], a[36:39], a[8:11], 0
  v_mfma_f32_16x16x32_bf16 v[60:63], a[36:39], a[12:15], 0
  s_waitcnt lgkmcnt(6)
  v_mfma_f32_16x16x32_bf16 v[64:67], a[40:43], a[0:3], 0
  ds_read_b128 a[52:55], v12 offset:20480
  v_mfma_f32_16x16x32_bf16 v[68:71], a[40:43], a[4:7], 0
  v_mfma_f32_16x16x32_bf16 v[72:75], a[40:43], a[8:11], 0
  v_mfma_f32_16x16x32_bf16 v[76:79], a[40:43], a[12:15], 0
  s_waitcnt lgkmcnt(2)
  v_mfma_f32_16x16x32_bf16 v[80:83], a[44:47], a[0:3], 0
  ds_read_b128 a[56:59], v12 offset:24576
  v_mfma_f32_16x16x32_bf16 v[84:87], a[44:47], a[4:7], 0
  v_mfma_f32_16x16x32_bf16 v[88:91], a[44:47], a[8:11], 0
  s_waitcnt vmcnt(0)
  v_mfma_f32_16x16x32_bf16 v[92:95], a[44:47], a[12:15], 0
  s_waitcnt lgkmcnt(2)
  v_mfma_f32_16x16x32_bf16 v[96:99], a[48:51], a[0:3], 0
  ds_read_b128 a[60:63], v12 offset:28672
  v_mfma_f32_16x16x32_bf16 v[100:103], a[48:51], a[4:7], 0
  v_mfma_f32_16x16x32_bf16 v[104:107], a[48:51], a[8:11], 0
  v_mfma_f32_16x16x32_bf16 v[108:111], a[48:51], a[12:15], 0
  s_waitcnt lgkmcnt(2)
  v_mfma_f32_16x16x32_bf16 v[112:115], a[52:55], a[0:3], 0
  ds_read_b128 a[32:35], v12 offset:32768
  v_mfma_f32_16x16x32_bf16 v[116:119], a[52:55], a[4:7], 0
  v_mfma_f32_16x16x32_bf16 v[120:123], a[52:55], a[8:11], 0
  v_mfma_f32_16x16x32_bf16 v[124:127], a[52:55], a[12:15], 0
  s_waitcnt lgkmcnt(2)
  v_mfma_f32_16x16x32_bf16 v[128:131], a[56:59], a[0:3], 0
  ds_read_b128 a[36:39], v13 offset:0
  v_mfma_f32_16x16x32_bf16 v[132:135], a[56:59], a[4:7], 0
  v_mfma_f32_16x16x32_bf16 v[136:139], a[56:59], a[8:11], 0
  v_mfma_f32_16x16x32_bf16 v[140:143], a[56:59], a[12:15], 0
  s_waitcnt lgkmcnt(2)
  v_mfma_f32_16x16x32_bf16 v[144:147], a[60:63], a[0:3], 0
  ds_read_b128 a[40:43], v13 offset:4096
  v_mfma_f32_16x16x32_bf16 v[148:151], a[60:63], a[4:7], 0
  v_mfma_f32_16x16x32_bf16 v[152:155], a[60:63], a[8:11], 0
  v_mfma_f32_16x16x32_bf16 v[156:159], a[60:63], a[12:15], 0
  s_waitcnt lgkmcnt(2)
  v_mfma_f32_16x16x32_bf16 v[160:163], a[32:35], a[0:3], 0
  ds_read_b128 a[44:47], v13 offset:8192
  v_mfma_f32_16x16x32_bf16 v[164:167], a[32:35], a[4:7], 0
  v_mfma_f32_16x16x32_bf16 v[168:171], a[32:35], a[8:11], 0
  v_mfma_f32_16x16x32_bf16 v[172:175], a[32:35], a[12:15], 0
  s_waitcnt lgkmcnt(2)
  v_mfma_f32_16x16x32_bf16 v[32:35], a[36:39], a[16:19], v[32:35]
  ds_read_b128 a[48:51], v13 offset:12288
  v_mfma_f32_16x16x32_bf16 v[36:39], a[36:39], a[20:23], v[36:39]
  v_mfma_f32_16x16x32_bf16 v[40:43], a[36:39], a[24:27], v[40:43]
  v_mfma_f32_16x16x32_bf16 v[44:47], a[36:39], a[28:31], v[44:47]
  s_waitcnt lgkmcnt(2)
  v_mfma_f32_16x16x32_bf16 v[48:51], a[40:43], a[16:19], v[48:51]
  ds_read_b128 a[52:55], v13 offset:16384
  v_mfma_f32_16x16x32_bf16 v[52:55], a[40:43], a[20:23], v[52:55]
  v_mfma_f32_16x16x32_bf16 v[56:59], a[40:43], a[24:27], v[56:59]
  v_mfma_f32_16x16x32_bf16 v[60:63], a[40:43], a[28:31], v[60:63]
  s_waitcnt lgkmcnt(2)
  v_mfma_f32_16x16x32_bf16 v[64:67], a[44:47], a[16:19], v[64:67]
  ds_read_b128 a[56:59], v13 offset:20480
  v_mfma_f32_16x16x32_bf16 v[68:71], a[44:47], a[20:23], v[68:71]
  v_mfma_f32_16x16x32_bf16 v[72:75], a[44:47], a[24:27], v[72:75]
  v_mfma_f32_16x16x32_bf16 v[76:79], a[44:47], a[28:31], v[76:79]
  s_waitcnt lgkmcnt(2)
  v_mfma_f32_16x16x32_bf16 v[80:83], a[48:51], a[16:19], v[80:83]
  ds_read_b128 a[60:63], v13 offset:24576
  v_mfma_f32_16x16x32_bf16 v[84:87], a[48:51], a[20:23], v[84:87]
  v_mfma_f32_16x16x32_bf16 v[88:91], a[48:51], a[24:27], v[88:91]
  v_mfma_f32_16x16x32_bf16 v[92:95], a[48:51], a[28:31], v[92:95]
  s_waitcnt lgkmcnt(2)
  v_mfma_f32_16x16x32_bf16 v[96:99], a[52:55], a[16:19], v[96:99]
  ds_read_b128 a[32:35], v13 offset:28672
  ds_read_b128 a[36:39], v13 offset:32768
  v_mfma_f32_16x16x32_bf16 v[100:103], a[52:55], a[20:23], v[100:103]
  v_mfma_f32_16x16x32_bf16 v[104:107], a[52:55], a[24:27], v[104:107]
  v_mfma_f32_16x16x32_bf16 v[108:111], a[52:55], a[28:31], v[108:111]
  s_waitcnt lgkmcnt(3)
  v_mfma_f32_16x16x32_bf16 v[112:115], a[56:59], a[16:19], v[112:115]
  v_mfma_f32_16x16x32_bf16 v[116:119], a[56:59], a[20:23], v[116:119]
  v_mfma_f32_16x16x32_bf16 v[120:123], a[56:59], a[24:27], v[120:123]
  s_waitcnt lgkmcnt(0)
  s_barrier
  ds_read_b128 a[0:3], v7 offset:16384
  v_mfma_f32_16x16x32_bf16 v[124:127], a[56:59], a[28:31], v[124:127]
  ds_read_b128 a[4:7], v7 offset:17408
  ds_read_b128 a[8:11], v7 offset:18432
  v_mfma_f32_16x16x32_bf16 v[128:131], a[60:63], a[16:19], v[128:131]
  ds_read_b128 a[12:15], v7 offset:19456
  ds_read_b128 a[40:43], v14 offset:0
  v_mfma_f32_16x16x32_bf16 v[132:135], a[60:63], a[20:23], v[132:135]
  v_mfma_f32_16x16x32_bf16 v[136:139], a[60:63], a[24:27], v[136:139]
  v_mfma_f32_16x16x32_bf16 v[140:143], a[60:63], a[28:31], v[140:143]
  v_mfma_f32_16x16x32_bf16 v[144:147], a[32:35], a[16:19], v[144:147]
  ds_read_b128 a[44:47], v14 offset:4096
  v_mfma_f32_16x16x32_bf16 v[148:151], a[32:35], a[20:23], v[148:151]
  v_mfma_f32_16x16x32_bf16 v[152:155], a[32:35], a[24:27], v[152:155]
  v_mfma_f32_16x16x32_bf16 v[156:159], a[32:35], a[28:31], v[156:159]
  v_mfma_f32_16x16x32_bf16 v[160:163], a[36:39], a[16:19], v[160:163]
  ds_read_b128 a[48:51], v14 offset:8192
  ds_read_b128 a[16:19], v8 offset:16384
  v_mfma_f32_16x16x32_bf16 v[164:167], a[36:39], a[20:23], v[164:167]
  ds_read_b128 a[20:23], v8 offset:17408
  v_mfma_f32_16x16x32_bf16 v[168:171], a[36:39], a[24:27], v[168:171]
  ds_read_b128 a[24:27], v8 offset:18432
  v_mfma_f32_16x16x32_bf16 v[172:175], a[36:39], a[28:31], v[172:175]
  s_waitcnt lgkmcnt(5)
  ds_read_b128 a[28:31], v8 offset:19456
  v_mfma_f32_16x16x32_bf16 v[32:35], a[40:43], a[0:3], v[32:35]
  ds_read_b128 a[52:55], v14 offset:12288
  v_mfma_f32_16x16x32_bf16 v[36:39], a[40:43], a[4:7], v[36:39]
  v_mfma_f32_16x16x32_bf16 v[40:43], a[40:43], a[8:11], v[40:43]
  v_mfma_f32_16x16x32_bf16 v[44:47], a[40:43], a[12:15], v[44:47]
  s_waitcnt lgkmcnt(6)
  v_mfma_f32_16x16x32_bf16 v[48:51], a[44:47], a[0:3], v[48:51]
  ds_read_b128 a[56:59], v14 offset:16384
  v_mfma_f32_16x16x32_bf16 v[52:55], a[44:47], a[4:7], v[52:55]
  v_mfma_f32_16x16x32_bf16 v[56:59], a[44:47], a[8:11], v[56:59]
  v_mfma_f32_16x16x32_bf16 v[60:63], a[44:47], a[12:15], v[60:63]
  s_waitcnt lgkmcnt(6)
  v_mfma_f32_16x16x32_bf16 v[64:67], a[48:51], a[0:3], v[64:67]
  ds_read_b128 a[60:63], v14 offset:20480
  v_mfma_f32_16x16x32_bf16 v[68:71], a[48:51], a[4:7], v[68:71]
  v_mfma_f32_16x16x32_bf16 v[72:75], a[48:51], a[8:11], v[72:75]
  v_mfma_f32_16x16x32_bf16 v[76:79], a[48:51], a[12:15], v[76:79]
  s_waitcnt lgkmcnt(2)
  v_mfma_f32_16x16x32_bf16 v[80:83], a[52:55], a[0:3], v[80:83]
  ds_read_b128 a[32:35], v14 offset:24576
  v_mfma_f32_16x16x32_bf16 v[84:87], a[52:55], a[4:7], v[84:87]
  v_mfma_f32_16x16x32_bf16 v[88:91], a[52:55], a[8:11], v[88:91]
  v_mfma_f32_16x16x32_bf16 v[92:95], a[52:55], a[12:15], v[92:95]
  s_waitcnt lgkmcnt(2)
  v_mfma_f32_16x16x32_bf16 v[96:99], a[56:59], a[0:3], v[96:99]
  ds_read_b128 a[36:39], v14 offset:28672
  v_mfma_f32_16x16x32_bf16 v[100:103], a[56:59], a[4:7], v[100:103]
  v_mfma_f32_16x16x32_bf16 v[104:107], a[56:59], a[8:11], v[104:107]
  v_mfma_f32_16x16x32_bf16 v[108:111], a[56:59], a[12:15], v[108:111]
  s_waitcnt lgkmcnt(2)
  v_mfma_f32_16x16x32_bf16 v[112:115], a[60:63], a[0:3], v[112:115]
  ds_read_b128 a[40:43], v14 offset:32768
  v_mfma_f32_16x16x32_bf16 v[116:119], a[60:63], a[4:7], v[116:119]
  v_mfma_f32_16x16x32_bf16 v[120:123], a[60:63], a[8:11], v[120:123]
  v_mfma_f32_16x16x32_bf16 v[124:127], a[60:63], a[12:15], v[124:127]
  s_waitcnt lgkmcnt(2)
  v_mfma_f32_16x16x32_bf16 v[128:131], a[32:35], a[0:3], v[128:131]
  ds_read_b128 a[44:47], v15 offset:0
  v_mfma_f32_16x16x32_bf16 v[132:135], a[32:35], a[4:7], v[132:135]
  v_mfma_f32_16x16x32_bf16 v[136:139], a[32:35], a[8:11], v[136:139]
  v_mfma_f32_16x16x32_bf16 v[140:143], a[32:35], a[12:15], v[140:143]
  s_waitcnt lgkmcnt(2)
  v_mfma_f32_16x16x32_bf16 v[144:147], a[36:39], a[0:3], v[144:147]
  ds_read_b128 a[48:51], v15 offset:4096
  v_mfma_f32_16x16x32_bf16 v[148:151], a[36:39], a[4:7], v[148:151]
  v_mfma_f32_16x16x32_bf16 v[152:155], a[36:39], a[8:11], v[152:155]
  v_mfma_f32_16x16x32_bf16 v[156:159], a[36:39], a[12:15], v[156:159]
  s_waitcnt lgkmcnt(2)
  v_mfma_f32_16x16x32_bf16 v[160:163], a[40:43], a[0:3], v[160:163]
  ds_read_b128 a[52:55], v15 offset:8192
  v_mfma_f32_16x16x32_bf16 v[164:167], a[40:43], a[4:7], v[164:167]
  v_mfma_f32_16x16x32_bf16 v[168:171], a[40:43], a[8:11], v[168:171]
  v_mfma_f32_16x16x32_bf16 v[172:175], a[40:43], a[12:15], v[172:175]
  s_waitcnt lgkmcnt(2)
  v_mfma_f32_16x16x32_bf16 v[32:35], a[44:47], a[16:19], v[32:35]
  ds_read_b128 a[56:59], v15 offset:12288
  v_mfma_f32_16x16x32_bf16 v[36:39], a[44:47], a[20:23], v[36:39]
  v_mfma_f32_16x16x32_bf16 v[40:43], a[44:47], a[24:27], v[40:43]
  v_mfma_f32_16x16x32_bf16 v[44:47], a[44:47], a[28:31], v[44:47]
  s_waitcnt lgkmcnt(2)
  v_mfma_f32_16x16x32_bf16 v[48:51], a[48:51], a[16:19], v[48:51]
  ds_read_b128 a[60:63], v15 offset:16384
  v_mfma_f32_16x16x32_bf16 v[52:55], a[48:51], a[20:23], v[52:55]
  v_mfma_f32_16x16x32_bf16 v[56:59], a[48:51], a[24:27], v[56:59]
  v_mfma_f32_16x16x32_bf16 v[60:63], a[48:51], a[28:31], v[60:63]
  s_waitcnt lgkmcnt(2)
  v_mfma_f32_16x16x32_bf16 v[64:67], a[52:55], a[16:19], v[64:67]
  ds_read_b128 a[32:35], v15 offset:20480
  v_mfma_f32_16x16x32_bf16 v[68:71], a[52:55], a[20:23], v[68:71]
  v_mfma_f32_16x16x32_bf16 v[72:75], a[52:55], a[24:27], v[72:75]
  v_mfma_f32_16x16x32_bf16 v[76:79], a[52:55], a[28:31], v[76:79]
  s_waitcnt lgkmcnt(2)
  v_mfma_f32_16x16x32_bf16 v[80:83], a[56:59], a[16:19], v[80:83]
  ds_read_b128 a[36:39], v15 offset:24576
  v_mfma_f32_16x16x32_bf16 v[84:87], a[56:59], a[20:23], v[84:87]
  v_mfma_f32_16x16x32_bf16 v[88:91], a[56:59], a[24:27], v[88:91]
  v_mfma_f32_16x16x32_bf16 v[92:95], a[56:59], a[28:31], v[92:95]
  s_waitcnt lgkmcnt(2)
  v_mfma_f32_16x16x32_bf16 v[96:99], a[60:63], a[16:19], v[96:99]
  ds_read_b128 a[40:43], v15 offset:28672
  ds_read_b128 a[44:47], v15 offset:32768
  v_mfma_f32_16x16x32_bf16 v[100:103], a[60:63], a[20:23], v[100:103]
  v_mfma_f32_16x16x32_bf16 v[104:107], a[60:63], a[24:27], v[104:107]
  v_mfma_f32_16x16x32_bf16 v[108:111], a[60:63], a[28:31], v[108:111]
  s_waitcnt lgkmcnt(3)
  v_mfma_f32_16x16x32_bf16 v[112:115], a[32:35], a[16:19], v[112:115]
  v_mfma_f32_16x16x32_bf16 v[116:119], a[32:35], a[20:23], v[116:119]
  v_mfma_f32_16x16x32_bf16 v[120:123], a[32:35], a[24:27], v[120:123]
  s_waitcnt lgkmcnt(0)
  s_barrier
  ds_read_b128 a[0:3], v7 offset:0
  v_mfma_f32_16x16x32_bf16 v[124:127], a[32:35], a[28:31], v[124:127]
  ds_read_b128 a[4:7], v7 offset:1024
  ds_read_b128 a[8:11], v7 offset:2048
  v_mfma_f32_16x16x32_bf16 v[128:131], a[36:39], a[16:19], v[128:131]
  ds_read_b128 a[12:15], v7 offset:3072
  ds_read_b128 a[48:51], v16 offset:0
  v_mfma_f32_16x16x32_bf16 v[132:135], a[36:39], a[20:23], v[132:135]
  v_mfma_f32_16x16x32_bf16 v[136:139], a[36:39], a[24:27], v[136:139]
  v_mfma_f32_16x16x32_bf16 v[140:143], a[36:39], a[28:31], v[140:143]
  v_mfma_f32_16x16x32_bf16 v[144:147], a[40:43], a[16:19], v[144:147]
  ds_read_b128 a[52:55], v16 offset:4096
  v_mfma_f32_16x16x32_bf16 v[148:151], a[40:43], a[20:23], v[148:151]
  v_mfma_f32_16x16x32_bf16 v[152:155], a[40:43], a[24:27], v[152:155]
  v_mfma_f32_16x16x32_bf16 v[156:159], a[40:43], a[28:31], v[156:159]
  v_mfma_f32_16x16x32_bf16 v[160:163], a[44:47], a[16:19], v[160:163]
  ds_read_b128 a[56:59], v16 offset:8192
  ds_read_b128 a[16:19], v8 offset:0
  v_mfma_f32_16x16x32_bf16 v[164:167], a[44:47], a[20:23], v[164:167]
  ds_read_b128 a[20:23], v8 offset:1024
  v_mfma_f32_16x16x32_bf16 v[168:171], a[44:47], a[24:27], v[168:171]
  ds_read_b128 a[24:27], v8 offset:2048
  v_mfma_f32_16x16x32_bf16 v[172:175], a[44:47], a[28:31], v[172:175]
  s_waitcnt lgkmcnt(5)
  ds_read_b128 a[28:31], v8 offset:3072
  v_mfma_f32_16x16x32_bf16 v[32:35], a[48:51], a[0:3], v[32:35]
  ds_read_b128 a[60:63], v16 offset:12288
  v_mfma_f32_16x16x32_bf16 v[36:39], a[48:51], a[4:7], v[36:39]
  v_mfma_f32_16x16x32_bf16 v[40:43], a[48:51], a[8:11], v[40:43]
  v_mfma_f32_16x16x32_bf16 v[44:47], a[48:51], a[12:15], v[44:47]
  s_waitcnt lgkmcnt(6)
  v_mfma_f32_16x16x32_bf16 v[48:51], a[52:55], a[0:3], v[48:51]
  ds_read_b128 a[32:35], v16 offset:16384
  v_mfma_f32_16x16x32_bf16 v[52:55], a[52:55], a[4:7], v[52:55]
  v_mfma_f32_16x16x32_bf16 v[56:59], a[52:55], a[8:11], v[56:59]
  v_mfma_f32_16x16x32_bf16 v[60:63], a[52:55], a[12:15], v[60:63]
  s_waitcnt lgkmcnt(6)
  v_mfma_f32_16x16x32_bf16 v[64:67], a[56:59], a[0:3], v[64:67]
  ds_read_b128 a[36:39], v16 offset:20480
  v_mfma_f32_16x16x32_bf16 v[68:71], a[56:59], a[4:7], v[68:71]
  v_mfma_f32_16x16x32_bf16 v[72:75], a[56:59], a[8:11], v[72:75]
  v_mfma_f32_16x16x32_bf16 v[76:79], a[56:59], a[12:15], v[76:79]
  s_waitcnt lgkmcnt(2)
  v_mfma_f32_16x16x32_bf16 v[80:83], a[60:63], a[0:3], v[80:83]
  ds_read_b128 a[40:43], v16 offset:24576
  v_mfma_f32_16x16x32_bf16 v[84:87], a[60:63], a[4:7], v[84:87]
  v_mfma_f32_16x16x32_bf16 v[88:91], a[60:63], a[8:11], v[88:91]
  v_mfma_f32_16x16x32_bf16 v[92:95], a[60:63], a[12:15], v[92:95]
  s_waitcnt lgkmcnt(2)
  v_mfma_f32_16x16x32_bf16 v[96:99], a[32:35], a[0:3], v[96:99]
  ds_read_b128 a[44:47], v16 offset:28672
  v_mfma_f32_16x16x32_bf16 v[100:103], a[32:35], a[4:7], v[100:103]
L_w1b:
  s_cbranch_execz L_wret1b
  v_mfma_f32_16x16x32_bf16 v[104:107], a[32:35], a[8:11], v[104:107]
  v_mfma_f32_16x16x32_bf16 v[108:111], a[32:35], a[12:15], v[108:111]
  s_waitcnt lgkmcnt(2)
  v_mfma_f32_16x16x32_bf16 v[112:115], a[36:39], a[0:3], v[112:115]
  ds_read_b128 a[48:51], v16 offset:32768
  v_mfma_f32_16x16x32_bf16 v[116:119], a[36:39], a[4:7], v[116:119]
  v_mfma_f32_16x16x32_bf16 v[120:123], a[36:39], a[8:11], v[120:123]
  v_mfma_f32_16x16x32_bf16 v[124:127], a[36:39], a[12:15], v[124:127]
  s_waitcnt lgkmcnt(2)
  v_mfma_f32_16x16x32_bf16 v[128:131], a[40:43], a[0:3], v[128:131]
  ds_read_b128 a[52:55], v17 offset:0
  v_mfma_f32_16x16x32_bf16 v[132:135], a[40:43], a[4:7], v[132:135]
  v_mfma_f32_16x16x32_bf16 v[136:139], a[40:43], a[8:11], v[136:139]
  v_mfma_f32_16x16x32_bf16 v[140:143], a[40:43], a[12:15], v[140:143]
  s_waitcnt lgkmcnt(2)
  v_mfma_f32_16x16x32_bf16 v[144:147], a[44:47], a[0:3], v[144:147]
  ds_read_b128 a[56:59], v17 offset:4096
  v_mfma_f32_16x16x32_bf16 v[148:151], a[44:47], a[4:7], v[148:151]
  v_mfma_f32_16x16x32_bf16 v[152:155], a[44:47], a[8:11], v[152:155]
  v_mfma_f32_16x16x32_bf16 v[156:159], a[44:47], a[12:15], v[156:159]
  s_waitcnt lgkmcnt(2)
  v_mfma_f32_16x16x32_bf16 v[160:163], a[48:51], a[0:3], v[160:163]
  ds_read_b128 a[60:63], v17 offset:8192
  v_mfma_f32_16x16x32_bf16 v[164:167], a[48:51], a[4:7], v[164:167]
  v_mfma_f32_16x16x32_bf16 v[168:171], a[48:51], a[8:11], v[168:171]
  v_mfma_f32_16x16x32_bf16 v[172:175], a[48:51], a[12:15], v[172:175]
  s_waitcnt lgkmcnt(2)
  v_mfma_f32_16x16x32_bf16 v[32:35], a[52:55], a[16:19], v[32:35]
  ds_read_b128 a[32:35], v17 offset:12288
  v_mfma_f32_16x16x32_bf16 v[36:39], a[52:55], a[20:23], v[36:39]
  v_mfma_f32_16x16x32_bf16 v[40:43], a[52:55], a[24:27], v[40:43]
  v_mfma_f32_16x16x32_bf16 v[44:47], a[52:55], a[28:31], v[44:47]
  s_waitcnt lgkmcnt(2)
  v_mfma_f32_16x16x32_bf16 v[48:51], a[56:59], a[16:19], v[48:51]
  ds_read_b128 a[36:39], v17 offset:16384
  v_mfma_f32_16x16x32_bf16 v[52:55], a[56:59], a[20:23], v[52:55]
  v_mfma_f32_16x16x32_bf16 v[56:59], a[56:59], a[24:27], v[56:59]
  v_mfma_f32_16x16x32_bf16 v[60:63], a[56:59], a[28:31], v[60:63]
  s_waitcnt lgkmcnt(2)
  v_mfma_f32_16x16x32_bf16 v[64:67], a[60:63], a[16:19], v[64:67]
  ds_read_b128 a[40:43], v17 offset:20480
  v_mfma_f32_16x16x32_bf16 v[68:71], a[60:63], a[20:23], v[68:71]
  v_mfma_f32_16x16x32_bf16 v[72:75], a[60:63], a[24:27], v[72:75]
  v_mfma_f32_16x16x32_bf16 v[76:79], a[60:63], a[28:31], v[76:79]
  s_waitcnt lgkmcnt(2)
  v_mfma_f32_16x16x32_bf16 v[80:83], a[32:35], a[16:19], v[80:83]
  ds_read_b128 a[44:47], v17 offset:24576
  v_mfma_f32_16x16x32_bf16 v[84:87], a[32:35], a[20:23], v[84:87]
  v_mfma_f32_16x16x32_bf16 v[88:91], a[32:35], a[24:27], v[88:91]
  v_mfma_f32_16x16x32_bf16 v[92:95], a[32:35], a[28:31], v[92:95]
  s_waitcnt lgkmcnt(2)
  v_mfma_f32_16x16x32_bf16 v[96:99], a[36:39], a[16:19], v[96:99]
  ds_read_b128 a[48:51], v17 offset:28672
  ds_read_b128 a[52:55], v17 offset:32768
  v_mfma_f32_16x16x32_bf16 v[100:103], a[36:39], a[20:23], v[100:103]
  v_mfma_f32_16x16x32_bf16 v[104:107], a[36:39], a[24:27], v[104:107]
  v_mfma_f32_16x16x32_bf16 v[108:111], a[36:39], a[28:31], v[108:111]
  s_waitcnt lgkmcnt(3)
  v_mfma_f32_16x16x32_bf16 v[112:115], a[40:43], a[16:19], v[112:115]
  v_mfma_f32_16x16x32_bf16 v[116:119], a[40:43], a[20:23], v[116:119]
  v_mfma_f32_16x16x32_bf16 v[120:123], a[40:43], a[24:27], v[120:123]
  s_waitcnt lgkmcnt(0)
  s_barrier
  ds_read_b128 a[0:3], v7 offset:16384
  v_mfma_f32_16x16x32_bf16 v[124:127], a[40:43], a[28:31], v[124:127]
  ds_read_b128 a[4:7], v7 offset:17408
  ds_read_b128 a[8:11], v7 offset:18432
  v_mfma_f32_16x16x32_bf16 v[128:131], a[44:47], a[16:19], v[128:131]
  ds_read_b128 a[12:15], v7 offset:19456
  ds_read_b128 a[56:59], v12 offset:0
  v_mfma_f32_16x16x32_bf16 v[132:135], a[44:47], a[20:23], v[132:135]
  v_mfma_f32_16x16x32_bf16 v[136:139], a[44:47], a[24:27], v[136:139]
  v_mfma_f32_16x16x32_bf16 v[140:143], a[44:47], a[28:31], v[140:143]
  v_mfma_f32_16x16x32_bf16 v[144:147], a[48:51], a[16:19], v[144:147]
  ds_read_b128 a[60:63], v12 offset:4096
  v_mfma_f32_16x16x32_bf16 v[148:151], a[48:51], a[20:23], v[148:151]
  v_mfma_f32_16x16x32_bf16 v[152:155], a[48:51], a[24:27], v[152:155]
  v_mfma_f32_16x16x32_bf16 v[156:159], a[48:51], a[28:31], v[156:159]
  v_mfma_f32_16x16x32_bf16 v[160:163], a[52:55], a[16:19], v[160:163]
  ds_read_b128 a[32:35], v12 offset:8192
  ds_read_b128 a[16:19], v8 offset:16384
  v_mfma_f32_16x16x32_bf16 v[164:167], a[52:55], a[20:23], v[164:167]
  ds_read_b128 a[20:23], v8 offset:17408
  v_mfma_f32_16x16x32_bf16 v[168:171], a[52:55], a[24:27], v[168:171]
  ds_read_b128 a[24:27], v8 offset:18432
  v_mfma_f32_16x16x32_bf16 v[172:175], a[52:55], a[28:31], v[172:175]
  s_waitcnt lgkmcnt(5)
  ds_read_b128 a[28:31], v8 offset:19456
  v_mfma_f32_16x16x32_bf16 v[32:35], a[56:59], a[0:3], v[32:35]
  ds_read_b128 a[36:39], v12 offset:12288
  v_mfma_f32_16x16x32_bf16 v[36:39], a[56:59], a[4:7], v[36:39]
  v_mfma_f32_16x16x32_bf16 v[40:43], a[56:59], a[8:11], v[40:43]
  v_mfma_f32_16x16x32_bf16 v[44:47], a[56:59], a[12:15], v[44:47]
  s_waitcnt lgkmcnt(6)
  v_mfma_f32_16x16x32_bf16 v[48:51], a[60:63], a[0:3], v[48:51]
  ds_read_b128 a[40:43], v12 offset:16384
  v_mfma_f32_16x16x32_bf16 v[52:55], a[60:63], a[4:7], v[52:55]
  v_mfma_f32_16x16x32_bf16 v[56:59], a[60:63], a[8:11], v[56:59]
  v_mfma_f32_16x16x32_bf16 v[60:63], a[60:63], a[12:15], v[60:63]
  s_waitcnt lgkmcnt(6)
  v_mfma_f32_16x16x32_bf16 v[64:67], a[32:35], a[0:3], v[64:67]
  ds_read_b128 a[44:47], v12 offset:20480
  v_mfma_f32_16x16x32_bf16 v[68:71], a[32:35], a[4:7], v[68:71]
  v_mfma_f32_16x16x32_bf16 v[72:75], a[32:35], a[8:11], v[72:75]
  v_mfma_f32_16x16x32_bf16 v[76:79], a[32:35], a[12:15], v[76:79]
  s_waitcnt lgkmcnt(2)
  v_mfma_f32_16x16x32_bf16 v[80:83], a[36:39], a[0:3], v[80:83]
  ds_read_b128 a[48:51], v12 offset:24576
  v_mfma_f32_16x16x32_bf16 v[84:87], a[36:39], a[4:7], v[84:87]
  v_mfma_f32_16x16x32_bf16 v[88:91], a[36:39], a[8:11], v[88:91]
  v_mfma_f32_16x16x32_bf16 v[92:95], a[36:39], a[12:15], v[92:95]
  s_waitcnt lgkmcnt(2)
  v_mfma_f32_16x16x32_bf16 v[96:99], a[40:43], a[0:3], v[96:99]
  ds_read_b128 a[52:55], v12 offset:28672
  v_mfma_f32_16x16x32_bf16 v[100:103], a[40:43], a[4:7], v[100:103]
  v_mfma_f32_16x16x32_bf16 v[104:107], a[40:43], a[8:11], v[104:107]
  v_mfma_f32_16x16x32_bf16 v[108:111], a[40:43], a[12:15], v[108:111]
  s_waitcnt lgkmcnt(2)
  v_mfma_f32_16x16x32_bf16 v[112:115], a[44:47], a[0:3], v[112:115]
  ds_read_b128 a[56:59], v12 offset:32768
  v_mfma_f32_16x16x32_bf16 v[116:119], a[44:47], a[4:7], v[116:119]
  v_mfma_f32_16x16x32_bf16 v[120:123], a[44:47], a[8:11], v[120:123]
  v_mfma_f32_16x16x32_bf16 v[124:127], a[44:47], a[12:15], v[124:127]
  s_waitcnt lgkmcnt(2)
  v_mfma_f32_16x16x32_bf16 v[128:131], a[48:51], a[0:3], v[128:131]
  ds_read_b128 a[60:63], v13 offset:0
  v_mfma_f32_16x16x32_bf16 v[132:135], a[48:51], a[4:7], v[132:135]
  v_mfma_f32_16x16x32_bf16 v[136:139], a[48:51], a[8:11], v[136:139]
  v_mfma_f32_16x16x32_bf16 v[140:143], a[48:51], a[12:15], v[140:143]
  s_waitcnt lgkmcnt(2)
  v_mfma_f32_16x16x32_bf16 v[144:147], a[52:55], a[0:3], v[144:147]
  ds_read_b128 a[32:35], v13 offset:4096
  v_mfma_f32_16x16x32_bf16 v[148:151], a[52:55], a[4:7], v[148:151]
  v_mfma_f32_16x16x32_bf16 v[152:155], a[52:55], a[8:11], v[152:155]
  v_mfma_f32_16x16x32_bf16 v[156:159], a[52:55], a[12:15], v[156:159]
  s_waitcnt lgkmcnt(2)
  v_mfma_f32_16x16x32_bf16 v[160:163], a[56:59], a[0:3], v[160:163]
  ds_read_b128 a[36:39], v13 offset:8192
  v_mfma_f32_16x16x32_bf16 v[164:167], a[56:59], a[4:7], v[164:167]
  v_mfma_f32_16x16x32_bf16 v[168:171], a[56:59], a[8:11], v[168:171]
  v_mfma_f32_16x16x32_bf16 v[172:175], a[56:59], a[12:15], v[172:175]
  s_waitcnt lgkmcnt(2)
  v_mfma_f32_16x16x32_bf16 v[32:35], a[60:63], a[16:19], v[32:35]
  ds_read_b128 a[40:43], v13 offset:12288
  v_mfma_f32_16x16x32_bf16 v[36:39], a[60:63], a[20:23], v[36:39]
  v_mfma_f32_16x16x32_bf16 v[40:43], a[60:63], a[24:27], v[40:43]
  v_mfma_f32_16x16x32_bf16 v[44:47], a[60:63], a[28:31], v[44:47]
  s_waitcnt lgkmcnt(2)
  v_mfma_f32_16x16x32_bf16 v[48:51], a[32:35], a[16:19], v[48:51]
  ds_read_b128 a[44:47], v13 offset:16384
  v_mfma_f32_16x16x32_bf16 v[52:55], a[32:35], a[20:23], v[52:55]
  v_mfma_f32_16x16x32_bf16 v[56:59], a[32:35], a[24:27], v[56:59]
  v_mfma_f32_16x16x32_bf16 v[60:63], a[32:35], a[28:31], v[60:63]
  s_waitcnt lgkmcnt(2)
  v_mfma_f32_16x16x32_bf16 v[64:67], a[36:39], a[16:19], v[64:67]
  ds_read_b128 a[48:51], v13 offset:20480
  v_mfma_f32_16x16x32_bf16 v[68:71], a[36:39], a[20:23], v[68:71]
  v_mfma_f32_16x16x32_bf16 v[72:75], a[36:39], a[24:27], v[72:75]
  v_mfma_f32_16x16x32_bf16 v[76:79], a[36:39], a[28:31], v[76:79]
  s_waitcnt lgkmcnt(2)
  v_mfma_f32_16x16x32_bf16 v[80:83], a[40:43], a[16:19], v[80:83]
  ds_read_b128 a[52:55], v13 offset:24576
  v_mfma_f32_16x16x32_bf16 v[84:87], a[40:43], a[20:23], v[84:87]
  v_mfma_f32_16x16x32_bf16 v[88:91], a[40:43], a[24:27], v[88:91]
  v_mfma_f32_16x16x32_bf16 v[92:95], a[40:43], a[28:31], v[92:95]
  s_waitcnt lgkmcnt(2)
  v_mfma_f32_16x16x32_bf16 v[96:99], a[44:47], a[16:19], v[96:99]
  ds_read_b128 a[56:59], v13 offset:28672
  ds_read_b128 a[60:63], v13 offset:32768
  v_mfma_f32_16x16x32_bf16 v[100:103], a[44:47], a[20:23], v[100:103]
  v_mfma_f32_16x16x32_bf16 v[104:107], a[44:47], a[24:27], v[104:107]
  v_mfma_f32_16x16x32_bf16 v[108:111], a[44:47], a[28:31], v[108:111]
  s_waitcnt lgkmcnt(3)
  v_mfma_f32_16x16x32_bf16 v[112:115], a[48:51], a[16:19], v[112:115]
  v_mfma_f32_16x16x32_bf16 v[116:119], a[48:51], a[20:23], v[116:119]
  v_mfma_f32_16x16x32_bf16 v[120:123], a[48:51], a[24:27], v[120:123]
  s_waitcnt lgkmcnt(0)
  s_barrier
  ds_read_b128 a[0:3], v7 offset:0
  v_mfma_f32_16x16x32_bf16 v[124:127], a[48:51], a[28:31], v[124:127]
  ds_read_b128 a[4:7], v7 offset:1024
  ds_read_b128 a[8:11], v7 offset:2048
  v_mfma_f32_16x16x32_bf16 v[128:131], a[52:55], a[16:19], v[128:131]
  ds_read_b128 a[12:15], v7 offset:3072
  ds_read_b128 a[32:35], v14 offset:0
  v_mfma_f32_16x16x32_bf16 v[132:135], a[52:55], a[20:23], v[132:135]
  v_mfma_f32_16x16x32_bf16 v[136:139], a[52:55], a[24:27], v[136:139]
  v_mfma_f32_16x16x32_bf16 v[140:143], a[52:55], a[28:31], v[140:143]
  v_mfma_f32_16x16x32_bf16 v[144:147], a[56:59], a[16:19], v[144:147]
  ds_read_b128 a[36:39], v14 offset:4096
  v_mfma_f32_16x16x32_bf16 v[148:151], a[56:59], a[20:23], v[148:151]
  v_mfma_f32_16x16x32_bf16 v[152:155], a[56:59], a[24:27], v[152:155]
  v_mfma_f32_16x16x32_bf16 v[156:159], a[56:59], a[28:31], v[156:159]
  v_mfma_f32_16x16x32_bf16 v[160:163], a[60:63], a[16:19], v[160:163]
  ds_read_b128 a[40:43], v14 offset:8192
  ds_read_b128 a[16:19], v8 offset:0
  v_mfma_f32_16x16x32_bf16 v[164:167], a[60:63], a[20:23], v[164:167]
  ds_read_b128 a[20:23], v8 offset:1024
  v_mfma_f32_16x16x32_bf16 v[168:171], a[60:63], a[24:27], v[168:171]
  ds_read_b128 a[24:27], v8 offset:2048
  v_mfma_f32_16x16x32_bf16 v[172:175], a[60:63], a[28:31], v[172:175]
  s_waitcnt lgkmcnt(5)
  ds_read_b128 a[28:31], v8 offset:3072
  v_mfma_f32_16x16x32_bf16 v[32:35], a[32:35], a[0:3], v[32:35]
  ds_read_b128 a[44:47], v14 offset:12288
  v_mfma_f32_16x16x32_bf16 v[36:39], a[32:35], a[4:7], v[36:39]
  v_mfma_f32_16x16x32_bf16 v[40:43], a[32:35], a[8:11], v[40:43]
  v_mfma_f32_16x16x32_bf16 v[44:47], a[32:35], a[12:15], v[44:47]
  s_waitcnt lgkmcnt(6)
  v_mfma_f32_16x16x32_bf16 v[48:51], a[36:39], a[0:3], v[48:51]
  ds_read_b128 a[48:51], v14 offset:16384
  v_mfma_f32_16x16x32_bf16 v[52:55], a[36:39], a[4:7], v[52:55]
  v_mfma_f32_16x16x32_bf16 v[56:59], a[36:39], a[8:11], v[56:59]
  v_mfma_f32_16x16x32_bf16 v[60:63], a[36:39], a[12:15], v[60:63]
  s_waitcnt lgkmcnt(6)
  v_mfma_f32_16x16x32_bf16 v[64:67], a[40:43], a[0:3], v[64:67]
  ds_read_b128 a[52:55], v14 offset:20480
  v_mfma_f32_16x16x32_bf16 v[68:71], a[40:43], a[4:7], v[68:71]
  v_mfma_f32_16x16x32_bf16 v[72:75], a[40:43], a[8:11], v[72:75]
  v_mfma_f32_16x16x32_bf16 v[76:79], a[40:43], a[12:15], v[76:79]
  s_waitcnt lgkmcnt(2)
  v_mfma_f32_16x16x32_bf16 v[80:83], a[44:47], a[0:3], v[80:83]
  ds_read_b128 a[56:59], v14 offset:24576
  v_mfma_f32_16x16x32_bf16 v[84:87], a[44:47], a[4:7], v[84:87]
  v_mfma_f32_16x16x32_bf16 v[88:91], a[44:47], a[8:11], v[88:91]
  v_mfma_f32_16x16x32_bf16 v[92:95], a[44:47], a[12:15], v[92:95]
  s_waitcnt lgkmcnt(2)
  v_mfma_f32_16x16x32_bf16 v[96:99], a[48:51], a[0:3], v[96:99]
  ds_read_b128 a[60:63], v14 offset:28672
  v_mfma_f32_16x16x32_bf16 v[100:103], a[48:51], a[4:7], v[100:103]
  v_mfma_f32_16x16x32_bf16 v[104:107], a[48:51], a[8:11], v[104:107]
  v_mfma_f32_16x16x32_bf16 v[108:111], a[48:51], a[12:15], v[108:111]
  s_waitcnt lgkmcnt(2)
  v_mfma_f32_16x16x32_bf16 v[112:115], a[52:55], a[0:3], v[112:115]
  ds_read_b128 a[32:35], v14 offset:32768
  v_mfma_f32_16x16x32_bf16 v[116:119], a[52:55], a[4:7], v[116:119]
  v_mfma_f32_16x16x32_bf16 v[120:123], a[52:55], a[8:11], v[120:123]
  v_mfma_f32_16x16x32_bf16 v[124:127], a[52:55], a[12:15], v[124:127]
  s_waitcnt lgkmcnt(2)
  v_mfma_f32_16x16x32_bf16 v[128:131], a[56:59], a[0:3], v[128:131]
  ds_read_b128 a[36:39], v15 offset:0
  v_mfma_f32_16x16x32_bf16 v[132:135], a[56:59], a[4:7], v[132:135]
  v_mfma_f32_16x16x32_bf16 v[136:139], a[56:59], a[8:11], v[136:139]
  v_mfma_f32_16x16x32_bf16 v[140:143], a[56:59], a[12:15], v[140:143]
  s_waitcnt lgkmcnt(2)
  v_mfma_f32_16x16x32_bf16 v[144:147], a[60:63], a[0:3], v[144:147]
  ds_read_b128 a[40:43], v15 offset:4096
  v_mfma_f32_16x16x32_bf16 v[148:151], a[60:63], a[4:7], v[148:151]
  v_mfma_f32_16x16x32_bf16 v[152:155], a[60:63], a[8:11], v[152:155]
  v_mfma_f32_16x16x32_bf16 v[156:159], a[60:63], a[12:15], v[156:159]
  s_waitcnt lgkmcnt(2)
  v_mfma_f32_16x16x32_bf16 v[160:163], a[32:35], a[0:3], v[160:163]
  ds_read_b128 a[44:47], v15 offset:8192
  v_mfma_f32_16x16x32_bf16 v[164:167], a[32:35], a[4:7], v[164:167]
  v_mfma_f32_16x16x32_bf16 v[168:171], a[32:35], a[8:11], v[168:171]
  v_mfma_f32_16x16x32_bf16 v[172:175], a[32:35], a[12:15], v[172:175]
  s_waitcnt lgkmcnt(2)
  v_mfma_f32_16x16x32_bf16 v[32:35], a[36:39], a[16:19], v[32:35]
  ds_read_b128 a[48:51], v15 offset:12288
  v_mfma_f32_16x16x32_bf16 v[36:39], a[36:39], a[20:23], v[36:39]
  v_mfma_f32_16x16x32_bf16 v[40:43], a[36:39], a[24:27], v[40:43]
  v_mfma_f32_16x16x32_bf16 v[44:47], a[36:39], a[28:31], v[44:47]
  s_waitcnt lgkmcnt(2)
  v_mfma_f32_16x16x32_bf16 v[48:51], a[40:43], a[16:19], v[48:51]
  ds_read_b128 a[52:55], v15 offset:16384
  v_mfma_f32_16x16x32_bf16 v[52:55], a[40:43], a[20:23], v[52:55]
  v_mfma_f32_16x16x32_bf16 v[56:59], a[40:43], a[24:27], v[56:59]
  v_mfma_f32_16x16x32_bf16 v[60:63], a[40:43], a[28:31], v[60:63]
  s_waitcnt lgkmcnt(2)
  v_mfma_f32_16x16x32_bf16 v[64:67], a[44:47], a[16:19], v[64:67]
  ds_read_b128 a[56:59], v15 offset:20480
  v_mfma_f32_16x16x32_bf16 v[68:71], a[44:47], a[20:23], v[68:71]
  v_mfma_f32_16x16x32_bf16 v[72:75], a[44:47], a[24:27], v[72:75]
  v_mfma_f32_16x16x32_bf16 v[76:79], a[44:47], a[28:31], v[76:79]
  s_waitcnt lgkmcnt(2)
  v_mfma_f32_16x16x32_bf16 v[80:83], a[48:51], a[16:19], v[80:83]
  ds_read_b128 a[60:63], v15 offset:24576
  v_mfma_f32_16x16x32_bf16 v[84:87], a[48:51], a[20:23], v[84:87]
  v_mfma_f32_16x16x32_bf16 v[88:91], a[48:51], a[24:27], v[88:91]
  v_mfma_f32_16x16x32_bf16 v[92:95], a[48:51], a[28:31], v[92:95]
  s_waitcnt lgkmcnt(2)
  v_mfma_f32_16x16x32_bf16 v[96:99], a[52:55], a[16:19], v[96:99]
  ds_read_b128 a[32:35], v15 offset:28672
  ds_read_b128 a[36:39], v15 offset:32768
  v_mfma_f32_16x16x32_bf16 v[100:103], a[52:55], a[20:23], v[100:103]
  v_mfma_f32_16x16x32_bf16 v[104:107], a[52:55], a[24:27], v[104:107]
  v_mfma_f32_16x16x32_bf16 v[108:111], a[52:55], a[28:31], v[108:111]
  s_waitcnt lgkmcnt(3)
  v_mfma_f32_16x16x32_bf16 v[112:115], a[56:59], a[16:19], v[112:115]
  v_mfma_f32_16x16x32_bf16 v[116:119], a[56:59], a[20:23], v[116:119]
  v_mfma_f32_16x16x32_bf16 v[120:123], a[56:59], a[24:27], v[120:123]
  s_waitcnt lgkmcnt(0)
  s_barrier
  ds_read_b128 a[0:3], v7 offset:16384
  v_mfma_f32_16x16x32_bf16 v[124:127], a[56:59], a[28:31], v[124:127]
  ds_read_b128 a[4:7], v7 offset:17408
  ds_read_b128 a[8:11], v7 offset:18432
  v_mfma_f32_16x16x32_bf16 v[128:131], a[60:63], a[16:19], v[128:131]
  ds_read_b128 a[12:15], v7 offset:19456
  ds_read_b128 a[40:43], v16 offset:0
  v_mfma_f32_16x16x32_bf16 v[132:135], a[60:63], a[20:23], v[132:135]
  v_mfma_f32_16x16x32_bf16 v[136:139], a[60:63], a[24:27], v[136:139]
  v_mfma_f32_16x16x32_bf16 v[140:143], a[60:63], a[28:31], v[140:143]
  v_mfma_f32_16x16x32_bf16 v[144:147], a[32:35], a[16:19], v[144:147]
  ds_read_b128 a[44:47], v16 offset:4096
  v_mfma_f32_16x16x32_bf16 v[148:151], a[32:35], a[20:23], v[148:151]
  v_mfma_f32_16x16x32_bf16 v[152:155], a[32:35], a[24:27], v[152:155]
  v_mfma_f32_16x16x32_bf16 v[156:159], a[32:35], a[28:31], v[156:159]
  v_mfma_f32_16x16x32_bf16 v[160:163], a[36:39], a[16:19], v[160:163]
  ds_read_b128 a[48:51], v16 offset:8192
  ds_read_b128 a[16:19], v8 offset:16384
  v_mfma_f32_16x16x32_bf16 v[164:167], a[36:39], a[20:23], v[164:167]
  ds_read_b128 a[20:23], v8 offset:17408
  v_mfma_f32_16x16x32_bf16 v[168:171], a[36:39], a[24:27], v[168:171]
  ds_read_b128 a[24:27], v8 offset:18432
  v_mfma_f32_16x16x32_bf16 v[172:175], a[36:39], a[28:31], v[172:175]
  s_waitcnt lgkmcnt(5)
  ds_read_b128 a[28:31], v8 offset:19456
  v_mfma_f32_16x16x32_bf16 v[32:35], a[40:43], a[0:3], v[32:35]
  ds_read_b128 a[52:55], v16 offset:12288
  v_mfma_f32_16x16x32_bf16 v[36:39], a[40:43], a[4:7], v[36:39]
  v_mfma_f32_16x16x32_bf16 v[40:43], a[40:43], a[8:11], v[40:43]
  v_mfma_f32_16x16x32_bf16 v[44:47], a[40:43], a[12:15], v[44:47]
  s_waitcnt lgkmcnt(6)
  v_mfma_f32_16x16x32_bf16 v[48:51], a[44:47], a[0:3], v[48:51]
  ds_read_b128 a[56:59], v16 offset:16384
  v_mfma_f32_16x16x32_bf16 v[52:55], a[44:47], a[4:7], v[52:55]
  v_mfma_f32_16x16x32_bf16 v[56:59], a[44:47], a[8:11], v[56:59]
  v_mfma_f32_16x16x32_bf16 v[60:63], a[44:47], a[12:15], v[60:63]
  s_waitcnt lgkmcnt(6)
  v_mfma_f32_16x16x32_bf16 v[64:67], a[48:51], a[0:3], v[64:67]
  ds_read_b128 a[60:63], v16 offset:20480
  v_mfma_f32_16x16x32_bf16 v[68:71], a[48:51], a[4:7], v[68:71]
  v_mfma_f32_16x16x32_bf16 v[72:75], a[48:51], a[8:11], v[72:75]
  v_mfma_f32_16x16x32_bf16 v[76:79], a[48:51], a[12:15], v[76:79]
  s_waitcnt lgkmcnt(2)
  v_mfma_f32_16x16x32_bf16 v[80:83], a[52:55], a[0:3], v[80:83]
  ds_read_b128 a[32:35], v16 offset:24576
  v_mfma_f32_16x16x32_bf16 v[84:87], a[52:55], a[4:7], v[84:87]
  v_mfma_f32_16x16x32_bf16 v[88:91], a[52:55], a[8:11], v[88:91]
  v_mfma_f32_16x16x32_bf16 v[92:95], a[52:55], a[12:15], v[92:95]
  s_waitcnt lgkmcnt(2)
  v_mfma_f32_16x16x32_bf16 v[96:99], a[56:59], a[0:3], v[96:99]
  ds_read_b128 a[36:39], v16 offset:28672
  v_mfma_f32_16x16x32_bf16 v[100:103], a[56:59], a[4:7], v[100:103]
  v_mfma_f32_16x16x32_bf16 v[104:107], a[56:59], a[8:11], v[104:107]
  v_mfma_f32_16x16x32_bf16 v[108:111], a[56:59], a[12:15], v[108:111]
  s_waitcnt lgkmcnt(2)
  v_mfma_f32_16x16x32_bf16 v[112:115], a[60:63], a[0:3], v[112:115]
  ds_read_b128 a[40:43], v16 offset:32768
  v_mfma_f32_16x16x32_bf16 v[116:119], a[60:63], a[4:7], v[116:119]
  v_mfma_f32_16x16x32_bf16 v[120:123], a[60:63], a[8:11], v[120:123]
  v_mfma_f32_16x16x32_bf16 v[124:127], a[60:63], a[12:15], v[124:127]
  s_waitcnt lgkmcnt(2)
  v_mfma_f32_16x16x32_bf16 v[128:131], a[32:35], a[0:3], v[128:131]
  ds_read_b128 a[44:47], v17 offset:0
  v_mfma_f32_16x16x32_bf16 v[132:135], a[32:35], a[4:7], v[132:135]
  v_mfma_f32_16x16x32_bf16 v[136:139], a[32:35], a[8:11], v[136:139]
  v_mfma_f32_16x16x32_bf16 v[140:143], a[32:35], a[12:15], v[140:143]
  s_waitcnt lgkmcnt(2)
  v_mfma_f32_16x16x32_bf16 v[144:147], a[36:39], a[0:3], v[144:147]
  ds_read_b128 a[48:51], v17 offset:4096
  v_mfma_f32_16x16x32_bf16 v[148:151], a[36:39], a[4:7], v[148:151]
  v_mfma_f32_16x16x32_bf16 v[152:155], a[36:39], a[8:11], v[152:155]
  v_mfma_f32_16x16x32_bf16 v[156:159], a[36:39], a[12:15], v[156:159]
  s_waitcnt lgkmcnt(2)
  v_mfma_f32_16x16x32_bf16 v[160:163], a[40:43], a[0:3], v[160:163]
  ds_read_b128 a[52:55], v17 offset:8192
  v_mfma_f32_16x16x32_bf16 v[164:167], a[40:43], a[4:7], v[164:167]
  v_mfma_f32_16x16x32_bf16 v[168:171], a[40:43], a[8:11], v[168:171]
  v_mfma_f32_16x16x32_bf16 v[172:175], a[40:43], a[12:15], v[172:175]
  s_waitcnt lgkmcnt(2)
  v_mfma_f32_16x16x32_bf16 v[32:35], a[44:47], a[16:19], v[32:35]
  ds_read_b128 a[56:59], v17 offset:12288
  v_mfma_f32_16x16x32_bf16 v[36:39], a[44:47], a[20:23], v[36:39]
  v_mfma_f32_16x16x32_bf16 v[40:43], a[44:47], a[24:27], v[40:43]
  v_mfma_f32_16x16x32_bf16 v[44:47], a[44:47], a[28:31], v[44:47]
  s_waitcnt lgkmcnt(2)
  v_mfma_f32_16x16x32_bf16 v[48:51], a[48:51], a[16:19], v[48:51]
  ds_read_b128 a[60:63], v17 offset:16384
  v_mfma_f32_16x16x32_bf16 v[52:55], a[48:51], a[20:23], v[52:55]
  v_mfma_f32_16x16x32_bf16 v[56:59], a[48:51], a[24:27], v[56:59]
  v_mfma_f32_16x16x32_bf16 v[60:63], a[48:51], a[28:31], v[60:63]
  s_waitcnt lgkmcnt(2)
  v_mfma_f32_16x16x32_bf16 v[64:67], a[52:55], a[16:19], v[64:67]
  ds_read_b128 a[32:35], v17 offset:20480
  v_mfma_f32_16x16x32_bf16 v[68:71], a[52:55], a[20:23], v[68:71]
  v_mfma_f32_16x16x32_bf16 v[72:75], a[52:55], a[24:27], v[72:75]
  v_mfma_f32_16x16x32_bf16 v[76:79], a[52:55], a[28:31], v[76:79]
  s_waitcnt lgkmcnt(2)
  v_mfma_f32_16x16x32_bf16 v[80:83], a[56:59], a[16:19], v[80:83]
  ds_read_b128 a[36:39], v17 offset:24576
  v_mfma_f32_16x16x32_bf16 v[84:87], a[56:59], a[20:23], v[84:87]
  v_mfma_f32_16x16x32_bf16 v[88:91], a[56:59], a[24:27], v[88:91]
  v_mfma_f32_16x16x32_bf16 v[92:95], a[56:59], a[28:31], v[92:95]
  s_waitcnt lgkmcnt(2)
  v_mfma_f32_16x16x32_bf16 v[96:99], a[60:63], a[16:19], v[96:99]
  ds_read_b128 a[40:43], v17 offset:28672
  ds_read_b128 a[44:47], v17 offset:32768
  v_mfma_f32_16x16x32_bf16 v[100:103], a[60:63], a[20:23], v[100:103]
  v_mfma_f32_16x16x32_bf16 v[104:107], a[60:63], a[24:27], v[104:107]
  v_mfma_f32_16x16x32_bf16 v[108:111], a[60:63], a[28:31], v[108:111]
  s_waitcnt lgkmcnt(3)
  v_mfma_f32_16x16x32_bf16 v[112:115], a[32:35], a[16:19], v[112:115]
  v_mfma_f32_16x16x32_bf16 v[116:119], a[32:35], a[20:23], v[116:119]
  v_mfma_f32_16x16x32_bf16 v[120:123], a[32:35], a[24:27], v[120:123]
  s_waitcnt lgkmcnt(0)
  s_barrier
  ds_read_b128 a[0:3], v7 offset:0
  v_mfma_f32_16x16x32_bf16 v[124:127], a[32:35], a[28:31], v[124:127]
  ds_read_b128 a[4:7], v7 offset:1024
  ds_read_b128 a[8:11], v7 offset:2048
  v_mfma_f32_16x16x32_bf16 v[128:131], a[36:39], a[16:19], v[128:131]
  ds_read_b128 a[12:15], v7 offset:3072
  ds_read_b128 a[48:51], v12 offset:0
  v_mfma_f32_16x16x32_bf16 v[132:135], a[36:39], a[20:23], v[132:135]
  v_mfma_f32_16x16x32_bf16 v[136:139], a[36:39], a[24:27], v[136:139]
  v_mfma_f32_16x16x32_bf16 v[140:143], a[36:39], a[28:31], v[140:143]
  v_mfma_f32_16x16x32_bf16 v[144:147], a[40:43], a[16:19], v[144:147]
  ds_read_b128 a[52:55], v12 offset:4096
  v_mfma_f32_16x16x32_bf16 v[148:151], a[40:43], a[20:23], v[148:151]
  v_mfma_f32_16x16x32_bf16 v[152:155], a[40:43], a[24:27], v[152:155]
  v_mfma_f32_16x16x32_bf16 v[156:159], a[40:43], a[28:31], v[156:159]
  v_mfma_f32_16x16x32_bf16 v[160:163], a[44:47], a[16:19], v[160:163]
  ds_read_b128 a[16:19], v8 offset:0
  ds_read_b128 a[56:59], v12 offset:8192
  v_mfma_f32_16x16x32_bf16 v[164:167], a[44:47], a[20:23], v[164:167]
  ds_read_b128 a[20:23], v8 offset:1024
  v_mfma_f32_16x16x32_bf16 v[168:171], a[44:47], a[24:27], v[168:171]
  ds_read_b128 a[24:27], v8 offset:2048
  v_mfma_f32_16x16x32_bf16 v[172:175], a[44:47], a[28:31], v[172:175]
  s_waitcnt lgkmcnt(5)
  ds_read_b128 a[28:31], v8 offset:3072
  v_mfma_f32_16x16x32_bf16 v[32:35], a[48:51], a[0:3], v[32:35]
  ds_read_b128 a[60:63], v12 offset:12288
  v_mfma_f32_16x16x32_bf16 v[36:39], a[48:51], a[4:7], v[36:39]
  v_mfma_f32_16x16x32_bf16 v[40:43], a[48:51], a[8:11], v[40:43]
  v_mfma_f32_16x16x32_bf16 v[44:47], a[48:51], a[12:15], v[44:47]
  s_waitcnt lgkmcnt(6)
  v_mfma_f32_16x16x32_bf16 v[48:51], a[52:55], a[0:3], v[48:51]
  ds_read_b128 a[32:35], v13 offset:0
  v_mfma_f32_16x16x32_bf16 v[52:55], a[52:55], a[4:7], v[52:55]
  v_mfma_f32_16x16x32_bf16 v[56:59], a[52:55], a[8:11], v[56:59]
  v_mfma_f32_16x16x32_bf16 v[60:63], a[52:55], a[12:15], v[60:63]
  s_waitcnt lgkmcnt(5)
  v_mfma_f32_16x16x32_bf16 v[64:67], a[56:59], a[0:3], v[64:67]
  ds_read_b128 a[36:39], v13 offset:4096
  v_mfma_f32_16x16x32_bf16 v[68:71], a[56:59], a[4:7], v[68:71]
  v_mfma_f32_16x16x32_bf16 v[72:75], a[56:59], a[8:11], v[72:75]
  v_mfma_f32_16x16x32_bf16 v[76:79], a[56:59], a[12:15], v[76:79]
  s_waitcnt lgkmcnt(2)
  v_mfma_f32_16x16x32_bf16 v[80:83], a[60:63], a[0:3], v[80:83]
  ds_read_b128 a[40:43], v13 offset:8192
  ds_read_b128 a[44:47], v13 offset:12288
  v_mfma_f32_16x16x32_bf16 v[84:87], a[60:63], a[4:7], v[84:87]
  v_mfma_f32_16x16x32_bf16 v[88:91], a[60:63], a[8:11], v[88:91]
  v_mfma_f32_16x16x32_bf16 v[92:95], a[60:63], a[12:15], v[92:95]
  s_waitcnt lgkmcnt(3)
  v_mfma_f32_16x16x32_bf16 v[32:35], a[32:35], a[16:19], v[32:35]
  v_mfma_f32_16x16x32_bf16 v[36:39], a[32:35], a[20:23], v[36:39]
  v_mfma_f32_16x16x32_bf16 v[40:43], a[32:35], a[24:27], v[40:43]
  s_waitcnt lgkmcnt(0)
  s_barrier
  ds_read_b128 a[0:3], v7 offset:16384
  v_mfma_f32_16x16x32_bf16 v[44:47], a[32:35], a[28:31], v[44:47]
  ds_read_b128 a[4:7], v7 offset:17408
  ds_read_b128 a[8:11], v7 offset:18432
  v_mfma_f32_16x16x32_bf16 v[48:51], a[36:39], a[16:19], v[48:51]
  ds_read_b128 a[12:15], v7 offset:19456
  ds_read_b128 a[48:51], v14 offset:0
  v_mfma_f32_16x16x32_bf16 v[52:55], a[36:39], a[20:23], v[52:55]
  v_mfma_f32_16x16x32_bf16 v[56:59], a[36:39], a[24:27], v[56:59]
  v_mfma_f32_16x16x32_bf16 v[60:63], a[36:39], a[28:31], v[60:63]
  v_mfma_f32_16x16x32_bf16 v[64:67], a[40:43], a[16:19], v[64:67]
  ds_read_b128 a[52:55], v14 offset:4096
  v_mfma_f32_16x16x32_bf16 v[68:71], a[40:43], a[20:23], v[68:71]
  v_mfma_f32_16x16x32_bf16 v[72:75], a[40:43], a[24:27], v[72:75]
  v_mfma_f32_16x16x32_bf16 v[76:79], a[40:43], a[28:31], v[76:79]
  v_mfma_f32_16x16x32_bf16 v[80:83], a[44:47], a[16:19], v[80:83]
  ds_read_b128 a[16:19], v8 offset:16384
  ds_read_b128 a[56:59], v14 offset:8192
  v_mfma_f32_16x16x32_bf16 v[84:87], a[44:47], a[20:23], v[84:87]
  ds_read_b128 a[20:23], v8 offset:17408
  v_mfma_f32_16x16x32_bf16 v[88:91], a[44:47], a[24:27], v[88:91]
  ds_read_b128 a[24:27], v8 offset:18432
  v_mfma_f32_16x16x32_bf16 v[92:95], a[44:47], a[28:31], v[92:95]
  s_waitcnt lgkmcnt(5)
  ds_read_b128 a[28:31], v8 offset:19456
  v_mfma_f32_16x16x32_bf16 v[32:35], a[48:51], a[0:3], v[32:35]
  ds_read_b128 a[60:63], v14 offset:12288
  v_mfma_f32_16x16x32_bf16 v[36:39], a[48:51], a[4:7], v[36:39]
  v_mfma_f32_16x16x32_bf16 v[40:43], a[48:51], a[8:11], v[40:43]
  v_mfma_f32_16x16x32_bf16 v[44:47], a[48:51], a[12:15], v[44:47]
  s_waitcnt lgkmcnt(6)
  v_mfma_f32_16x16x32_bf16 v[48:51], a[52:55], a[0:3], v[48:51]
  ds_read_b128 a[32:35], v15 offset:0
  v_mfma_f32_16x16x32_bf16 v[52:55], a[52:55], a[4:7], v[52:55]
  v_mfma_f32_16x16x32_bf16 v[56:59], a[52:55], a[8:11], v[56:59]
  v_mfma_f32_16x16x32_bf16 v[60:63], a[52:55], a[12:15], v[60:63]
  s_waitcnt lgkmcnt(5)
  v_mfma_f32_16x16x32_bf16 v[64:67], a[56:59], a[0:3], v[64:67]
  ds_read_b128 a[36:39], v15 offset:4096
  v_mfma_f32_16x16x32_bf16 v[68:71], a[56:59], a[4:7], v[68:71]
  v_mfma_f32_16x16x32_bf16 v[72:75], a[56:59], a[8:11], v[72:75]
  v_mfma_f32_16x16x32_bf16 v[76:79], a[56:59], a[12:15], v[76:79]
  s_waitcnt lgkmcnt(2)
  v_mfma_f32_16x16x32_bf16 v[80:83], a[60:63], a[0:3], v[80:83]
  ds_read_b128 a[40:43], v15 offset:8192
  v_mfma_f32_16x16x32_bf16 v[84:87], a[60:63], a[4:7], v[84:87]
  v_mfma_f32_16x16x32_bf16 v[88:91], a[60:63], a[8:11], v[88:91]
  v_mfma_f32_16x16x32_bf16 v[92:95], a[60:63], a[12:15], v[92:95]
  s_waitcnt lgkmcnt(2)
  v_mfma_f32_16x16x32_bf16 v[32:35], a[32:35], a[16:19], v[32:35]
  ds_read_b128 a[44:47], v15 offset:12288
  v_mfma_f32_16x16x32_bf16 v[36:39], a[32:35], a[20:23], v[36:39]
  v_mfma_f32_16x16x32_bf16 v[40:43], a[32:35], a[24:27], v[40:43]
  s_barrier
  ds_read_b128 a[0:3], v7 offset:37888
  v_mfma_f32_16x16x32_bf16 v[44:47], a[32:35], a[28:31], v[44:47]
  s_waitcnt lgkmcnt(3)
  ds_read_b128 a[4:7], v7 offset:38912
  ds_read_b128 a[8:11], v7 offset:39936
  v_mfma_f32_16x16x32_bf16 v[48:51], a[36:39], a[16:19], v[48:51]
  ds_read_b128 a[12:15], v7 offset:40960
  ds_read_b128 a[48:51], v16 offset:0
  v_mfma_f32_16x16x32_bf16 v[52:55], a[36:39], a[20:23], v[52:55]
  v_mfma_f32_16x16x32_bf16 v[56:59], a[36:39], a[24:27], v[56:59]
  v_mfma_f32_16x16x32_bf16 v[60:63], a[36:39], a[28:31], v[60:63]
  s_waitcnt lgkmcnt(6)
  v_mfma_f32_16x16x32_bf16 v[64:67], a[40:43], a[16:19], v[64:67]
  ds_read_b128 a[52:55], v16 offset:4096
  v_mfma_f32_16x16x32_bf16 v[68:71], a[40:43], a[20:23], v[68:71]
  v_mfma_f32_16x16x32_bf16 v[72:75], a[40:43], a[24:27], v[72:75]
  v_mfma_f32_16x16x32_bf16 v[76:79], a[40:43], a[28:31], v[76:79]
  s_waitcnt lgkmcnt(6)
  v_mfma_f32_16x16x32_bf16 v[80:83], a[44:47], a[16:19], v[80:83]
  ds_read_b128 a[16:19], v8 offset:37888
  ds_read_b128 a[56:59], v16 offset:8192
  v_mfma_f32_16x16x32_bf16 v[84:87], a[44:47], a[20:23], v[84:87]
  ds_read_b128 a[20:23], v8 offset:38912
  v_mfma_f32_16x16x32_bf16 v[88:91], a[44:47], a[24:27], v[88:91]
  ds_read_b128 a[24:27], v8 offset:39936
  v_mfma_f32_16x16x32_bf16 v[92:95], a[44:47], a[28:31], v[92:95]
  s_waitcnt lgkmcnt(5)
  ds_read_b128 a[28:31], v8 offset:40960
  v_mfma_f32_16x16x32_bf16 v[32:35], a[48:51], a[0:3], v[32:35]
  ds_read_b128 a[60:63], v16 offset:12288
  v_mfma_f32_16x16x32_bf16 v[36:39], a[48:51], a[4:7], v[36:39]
  v_mfma_f32_16x16x32_bf16 v[40:43], a[48:51], a[8:11], v[40:43]
  v_mfma_f32_16x16x32_bf16 v[44:47], a[48:51], a[12:15], v[44:47]
  s_waitcnt lgkmcnt(6)
  v_mfma_f32_16x16x32_bf16 v[48:51], a[52:55], a[0:3], v[48:51]
L_w2b:
  s_cbranch_execz L_wret1b
  ds_read_b128 a[32:35], v17 offset:0
  v_mfma_f32_16x16x32_bf16 v[52:55], a[52:55], a[4:7], v[52:55]
  v_mfma_f32_16x16x32_bf16 v[56:59], a[52:55], a[8:11], v[56:59]
  v_mfma_f32_16x16x32_bf16 v[60:63], a[52:55], a[12:15], v[60:63]
  s_waitcnt lgkmcnt(5)
  v_mfma_f32_16x16x32_bf16 v[64:67], a[56:59], a[0:3], v[64:67]
  ds_read_b128 a[36:39], v17 offset:4096
  v_mfma_f32_16x16x32_bf16 v[68:71], a[56:59], a[4:7], v[68:71]
  v_mfma_f32_16x16x32_bf16 v[72:75], a[56:59], a[8:11], v[72:75]
  v_mfma_f32_16x16x32_bf16 v[76:79], a[56:59], a[12:15], v[76:79]
  s_waitcnt lgkmcnt(2)
  v_mfma_f32_16x16x32_bf16 v[80:83], a[60:63], a[0:3], v[80:83]
  ds_read_b128 a[0:3], v7 offset:0
  ds_read_b128 a[40:43], v17 offset:8192
  v_mfma_f32_16x16x32_bf16 v[84:87], a[60:63], a[4:7], v[84:87]
  ds_read_b128 a[4:7], v7 offset:1024
  v_mfma_f32_16x16x32_bf16 v[88:91], a[60:63], a[8:11], v[88:91]
  ds_read_b128 a[8:11], v7 offset:2048
  v_mfma_f32_16x16x32_bf16 v[92:95], a[60:63], a[12:15], v[92:95]
  s_waitcnt lgkmcnt(5)
  ds_read_b128 a[12:15], v7 offset:3072
  v_mfma_f32_16x16x32_bf16 v[32:35], a[32:35], a[16:19], v[32:35]
  ds_read_b128 a[44:47], v17 offset:12288
  v_mfma_f32_16x16x32_bf16 v[36:39], a[32:35], a[20:23], v[36:39]
  v_mfma_f32_16x16x32_bf16 v[40:43], a[32:35], a[24:27], v[40:43]
  s_barrier
  v_mfma_f32_16x16x32_bf16 v[44:47], a[32:35], a[28:31], v[44:47]
  s_waitcnt lgkmcnt(6)
  v_mfma_f32_16x16x32_bf16 v[48:51], a[36:39], a[16:19], v[48:51]
  ds_read_b128 a[48:51], v12 offset:16384
  v_mfma_f32_16x16x32_bf16 v[52:55], a[36:39], a[20:23], v[52:55]
  v_mfma_f32_16x16x32_bf16 v[56:59], a[36:39], a[24:27], v[56:59]
  s_mov_b32 s6, 0
  v_mfma_f32_16x16x32_bf16 v[60:63], a[36:39], a[28:31], v[60:63]
  s_waitcnt lgkmcnt(5)
  v_cvt_pk_bf16_f32 v20, v32, v36
  v_cvt_pk_bf16_f32 v21, v40, v44
  v_mfma_f32_16x16x32_bf16 v[64:67], a[40:43], a[16:19], v[64:67]
  ds_read_b128 a[52:55], v12 offset:20480
  buffer_store_dwordx2 v[20:21], v4, s[36:39], s6 offen nt
  v_mfma_f32_16x16x32_bf16 v[68:71], a[40:43], a[20:23], v[68:71]
  v_cvt_pk_bf16_f32 v22, v33, v37
  v_cvt_pk_bf16_f32 v23, v41, v45
  v_mfma_f32_16x16x32_bf16 v[72:75], a[40:43], a[24:27], v[72:75]
  v_mfma_f32_16x16x32_bf16 v[76:79], a[40:43], a[28:31], v[76:79]
  s_waitcnt lgkmcnt(2)
  v_mfma_f32_16x16x32_bf16 v[80:83], a[44:47], a[16:19], v[80:83]
  ds_read_b128 a[16:19], v8 offset:0
  ds_read_b128 a[56:59], v12 offset:24576
  s_mov_b32 s6, 9216
  v_mfma_f32_16x16x32_bf16 v[84:87], a[44:47], a[20:23], v[84:87]
  ds_read_b128 a[20:23], v8 offset:1024
  buffer_store_dwordx2 v[22:23], v4, s[36:39], s6 offen nt
  v_mfma_f32_16x16x32_bf16 v[88:91], a[44:47], a[24:27], v[88:91]
  ds_read_b128 a[24:27], v8 offset:2048
  v_cvt_pk_bf16_f32 v24, v34, v38
  v_mfma_f32_16x16x32_bf16 v[92:95], a[44:47], a[28:31], v[92:95]
  s_waitcnt lgkmcnt(5)
  ds_read_b128 a[28:31], v8 offset:3072
  v_cvt_pk_bf16_f32 v25, v42, v46
  v_mfma_f32_16x16x32_bf16 v[96:99], a[48:51], a[0:3], v[96:99]
  ds_read_b128 a[60:63], v13 offset:16384
  s_mov_b32 s6, 18432
  v_mfma_f32_16x16x32_bf16 v[100:103], a[48:51], a[4:7], v[100:103]
  buffer_store_dwordx2 v[24:25], v4, s[36:39], s6 offen nt
  v_cvt_pk_bf16_f32 v26, v35, v39
  v_mfma_f32_16x16x32_bf16 v[104:107], a[48:51], a[8:11], v[104:107]
  v_cvt_pk_bf16_f32 v27, v43, v47
  v_mfma_f32_16x16x32_bf16 v[108:111], a[48:51], a[12:15], v[108:111]
  s_waitcnt lgkmcnt(6)
  v_mfma_f32_16x16x32_bf16 v[112:115], a[52:55], a[0:3], v[112:115]
  ds_read_b128 a[32:35], v13 offset:20480
  s_mov_b32 s6, 27648
  v_mfma_f32_16x16x32_bf16 v[116:119], a[52:55], a[4:7], v[116:119]
  buffer_store_dwordx2 v[26:27], v4, s[36:39], s6 offen nt
  v_cvt_pk_bf16_f32 v28, v48, v52
  v_mfma_f32_16x16x32_bf16 v[120:123], a[52:55], a[8:11], v[120:123]
  v_cvt_pk_bf16_f32 v29, v56, v60
  v_mfma_f32_16x16x32_bf16 v[124:127], a[52:55], a[12:15], v[124:127]
  s_waitcnt lgkmcnt(5)
  v_mfma_f32_16x16x32_bf16 v[128:131], a[56:59], a[0:3], v[128:131]
  ds_read_b128 a[0:3], v7 offset:16384
  ds_read_b128 a[36:39], v13 offset:24576
  s_mov_b32 s6, 294912
  v_mfma_f32_16x16x32_bf16 v[132:135], a[56:59], a[4:7], v[132:135]
  ds_read_b128 a[4:7], v7 offset:17408
  buffer_store_dwordx2 v[28:29], v4, s[36:39], s6 offen nt
  v_mfma_f32_16x16x32_bf16 v[136:139], a[56:59], a[8:11], v[136:139]
  s_barrier
  ds_read_b128 a[8:11], v7 offset:18432
  v_mfma_f32_16x16x32_bf16 v[140:143], a[56:59], a[12:15], v[140:143]
  s_waitcnt lgkmcnt(5)
  ds_read_b128 a[12:15], v7 offset:19456
  v_cvt_pk_bf16_f32 v30, v49, v53
  v_mfma_f32_16x16x32_bf16 v[96:99], a[60:63], a[16:19], v[96:99]
  ds_read_b128 a[40:43], v14 offset:16384
  v_cvt_pk_bf16_f32 v31, v57, v61
  s_mov_b32 s6, 304128
  v_mfma_f32_16x16x32_bf16 v[100:103], a[60:63], a[20:23], v[100:103]
  buffer_store_dwordx2 v[30:31], v4, s[36:39], s6 offen nt
  v_cvt_pk_bf16_f32 v20, v50, v54
  v_mfma_f32_16x16x32_bf16 v[104:107], a[60:63], a[24:27], v[104:107]
  v_cvt_pk_bf16_f32 v21, v58, v62
  v_mfma_f32_16x16x32_bf16 v[108:111], a[60:63], a[28:31], v[108:111]
  s_waitcnt lgkmcnt(6)
  v_mfma_f32_16x16x32_bf16 v[112:115], a[32:35], a[16:19], v[112:115]
  ds_read_b128 a[44:47], v14 offset:20480
  s_mov_b32 s6, 313344
  v_mfma_f32_16x16x32_bf16 v[116:119], a[32:35], a[20:23], v[116:119]
  buffer_store_dwordx2 v[20:21], v4, s[36:39], s6 offen nt
  v_cvt_pk_bf16_f32 v22, v51, v55
  v_mfma_f32_16x16x32_bf16 v[120:123], a[32:35], a[24:27], v[120:123]
  v_cvt_pk_bf16_f32 v23, v59, v63
  v_mfma_f32_16x16x32_bf16 v[124:127], a[32:35], a[28:31], v[124:127]
  s_waitcnt lgkmcnt(5)
  v_mfma_f32_16x16x32_bf16 v[128:131], a[36:39], a[16:19], v[128:131]
  ds_read_b128 a[16:19], v8 offset:16384
  ds_read_b128 a[48:51], v14 offset:24576
  s_mov_b32 s6, 322560
  v_mfma_f32_16x16x32_bf16 v[132:135], a[36:39], a[20:23], v[132:135]
  ds_read_b128 a[20:23], v8 offset:17408
  buffer_store_dwordx2 v[22:23], v4, s[36:39], s6 offen nt
  v_mfma_f32_16x16x32_bf16 v[136:139], a[36:39], a[24:27], v[136:139]
  ds_read_b128 a[24:27], v8 offset:18432
  v_cvt_pk_bf16_f32 v24, v64, v68
  v_mfma_f32_16x16x32_bf16 v[140:143], a[36:39], a[28:31], v[140:143]
  s_waitcnt lgkmcnt(5)
  ds_read_b128 a[28:31], v8 offset:19456
  v_cvt_pk_bf16_f32 v25, v72, v76
  v_mfma_f32_16x16x32_bf16 v[96:99], a[40:43], a[0:3], v[96:99]
  ds_read_b128 a[52:55], v15 offset:16384
  s_mov_b32 s6, 589824
  v_mfma_f32_16x16x32_bf16 v[100:103], a[40:43], a[4:7], v[100:103]
  buffer_store_dwordx2 v[24:25], v4, s[36:39], s6 offen nt
  v_cvt_pk_bf16_f32 v26, v65, v69
  v_mfma_f32_16x16x32_bf16 v[104:107], a[40:43], a[8:11], v[104:107]
  v_cvt_pk_bf16_f32 v27, v73, v77
  v_mfma_f32_16x16x32_bf16 v[108:111], a[40:43], a[12:15], v[108:111]
  s_waitcnt lgkmcnt(6)
  v_mfma_f32_16x16x32_bf16 v[112:115], a[44:47], a[0:3], v[112:115]
  ds_read_b128 a[56:59], v15 offset:20480
  s_mov_b32 s6, 599040
  v_mfma_f32_16x16x32_bf16 v[116:119], a[44:47], a[4:7], v[116:119]
  buffer_store_dwordx2 v[26:27], v4, s[36:39], s6 offen nt
  v_cvt_pk_bf16_f32 v28, v66, v70
  v_mfma_f32_16x16x32_bf16 v[120:123], a[44:47], a[8:11], v[120:123]
  v_cvt_pk_bf16_f32 v29, v74, v78
  v_mfma_f32_16x16x32_bf16 v[124:127], a[44:47], a[12:15], v[124:127]
  s_waitcnt lgkmcnt(5)
  v_mfma_f32_16x16x32_bf16 v[128:131], a[48:51], a[0:3], v[128:131]
  ds_read_b128 a[0:3], v7 offset:37888
  ds_read_b128 a[60:63], v15 offset:24576
  s_mov_b32 s6, 608256
  v_mfma_f32_16x16x32_bf16 v[132:135], a[48:51], a[4:7], v[132:135]
  ds_read_b128 a[4:7], v7 offset:38912
  buffer_store_dwordx2 v[28:29], v4, s[36:39], s6 offen nt
  v_mfma_f32_16x16x32_bf16 v[136:139], a[48:51], a[8:11], v[136:139]
  s_barrier
  ds_read_b128 a[8:11], v7 offset:39936
  v_mfma_f32_16x16x32_bf16 v[140:143], a[48:51], a[12:15], v[140:143]
  s_waitcnt lgkmcnt(5)
  ds_read_b128 a[12:15], v7 offset:40960
  v_cvt_pk_bf16_f32 v30, v67, v71
  v_mfma_f32_16x16x32_bf16 v[96:99], a[52:55], a[16:19], v[96:99]
  ds_read_b128 a[32:35], v16 offset:16384
  v_cvt_pk_bf16_f32 v31, v75, v79
  s_mov_b32 s6, 617472
  v_mfma_f32_16x16x32_bf16 v[100:103], a[52:55], a[20:23], v[100:103]
  buffer_store_dwordx2 v[30:31], v4, s[36:39], s6 offen nt
  v_cvt_pk_bf16_f32 v20, v80, v84
  v_mfma_f32_16x16x32_bf16 v[104:107], a[52:55], a[24:27], v[104:107]
  v_cvt_pk_bf16_f32 v21, v88, v92
  v_mfma_f32_16x16x32_bf16 v[108:111], a[52:55], a[28:31], v[108:111]
  s_waitcnt lgkmcnt(6)
  v_mfma_f32_16x16x32_bf16 v[112:115], a[56:59], a[16:19], v[112:115]
  ds_read_b128 a[36:39], v16 offset:20480
  s_mov_b32 s6, 884736
  v_mfma_f32_16x16x32_bf16 v[116:119], a[56:59], a[20:23], v[116:119]
  buffer_store_dwordx2 v[20:21], v4, s[36:39], s6 offen nt
  v_cvt_pk_bf16_f32 v22, v81, v85
  v_mfma_f32_16x16x32_bf16 v[120:123], a[56:59], a[24:27], v[120:123]
  v_cvt_pk_bf16_f32 v23, v89, v93
  v_mfma_f32_16x16x32_bf16 v[124:127], a[56:59], a[28:31], v[124:127]
  s_waitcnt lgkmcnt(5)
  v_mfma_f32_16x16x32_bf16 v[128:131], a[60:63], a[16:19], v[128:131]
  ds_read_b128 a[16:19], v8 offset:37888
  ds_read_b128 a[40:43], v16 offset:24576
  s_mov_b32 s6, 893952
  v_mfma_f32_16x16x32_bf16 v[132:135], a[60:63], a[20:23], v[132:135]
  ds_read_b128 a[20:23], v8 offset:38912
  buffer_store_dwordx2 v[22:23], v4, s[36:39], s6 offen nt
  v_mfma_f32_16x16x32_bf16 v[136:139], a[60:63], a[24:27], v[136:139]
  ds_read_b128 a[24:27], v8 offset:39936
  v_cvt_pk_bf16_f32 v24, v82, v86
  v_mfma_f32_16x16x32_bf16 v[140:143], a[60:63], a[28:31], v[140:143]
  s_waitcnt lgkmcnt(5)
  ds_read_b128 a[28:31], v8 offset:40960
  v_cvt_pk_bf16_f32 v25, v90, v94
  v_mfma_f32_16x16x32_bf16 v[96:99], a[32:35], a[0:3], v[96:99]
  ds_read_b128 a[44:47], v17 offset:16384
  s_mov_b32 s6, 903168
  v_mfma_f32_16x16x32_bf16 v[100:103], a[32:35], a[4:7], v[100:103]
  buffer_store_dwordx2 v[24:25], v4, s[36:39], s6 offen nt
  v_cvt_pk_bf16_f32 v26, v83, v87
  v_mfma_f32_16x16x32_bf16 v[104:107], a[32:35], a[8:11], v[104:107]
  v_cvt_pk_bf16_f32 v27, v91, v95
  v_mfma_f32_16x16x32_bf16 v[108:111], a[32:35], a[12:15], v[108:111]
  s_waitcnt lgkmcnt(6)
  v_mfma_f32_16x16x32_bf16 v[112:115], a[36:39], a[0:3], v[112:115]
  ds_read_b128 a[48:51], v17 offset:20480
  s_mov_b32 s6, 912384
  v_mfma_f32_16x16x32_bf16 v[116:119], a[36:39], a[4:7], v[116:119]
  buffer_store_dwordx2 v[26:27], v4, s[36:39], s6 offen nt
  v_mfma_f32_16x16x32_bf16 v[120:123], a[36:39], a[8:11], v[120:123]
  v_mfma_f32_16x16x32_bf16 v[124:127], a[36:39], a[12:15], v[124:127]
  s_waitcnt lgkmcnt(5)
  v_mfma_f32_16x16x32_bf16 v[128:131], a[40:43], a[0:3], v[128:131]
  ds_read_b128 a[0:3], v7 offset:0
  ds_read_b128 a[52:55], v17 offset:24576
  v_mfma_f32_16x16x32_bf16 v[132:135], a[40:43], a[4:7], v[132:135]
  ds_read_b128 a[4:7], v7 offset:1024
  v_mfma_f32_16x16x32_bf16 v[136:139], a[40:43], a[8:11], v[136:139]
  s_barrier
  ds_read_b128 a[8:11], v7 offset:2048
  v_mfma_f32_16x16x32_bf16 v[140:143], a[40:43], a[12:15], v[140:143]
  s_waitcnt lgkmcnt(5)
  ds_read_b128 a[12:15], v7 offset:3072
  v_mfma_f32_16x16x32_bf16 v[96:99], a[44:47], a[16:19], v[96:99]
  ds_read_b128 a[56:59], v12 offset:28672
  v_mfma_f32_16x16x32_bf16 v[100:103], a[44:47], a[20:23], v[100:103]
  v_mfma_f32_16x16x32_bf16 v[104:107], a[44:47], a[24:27], v[104:107]
  v_mfma_f32_16x16x32_bf16 v[108:111], a[44:47], a[28:31], v[108:111]
  s_waitcnt lgkmcnt(6)
  v_mfma_f32_16x16x32_bf16 v[112:115], a[48:51], a[16:19], v[112:115]
  ds_read_b128 a[60:63], v12 offset:32768
  v_mfma_f32_16x16x32_bf16 v[116:119], a[48:51], a[20:23], v[116:119]
  v_mfma_f32_16x16x32_bf16 v[120:123], a[48:51], a[24:27], v[120:123]
  v_mfma_f32_16x16x32_bf16 v[124:127], a[48:51], a[28:31], v[124:127]
  s_waitcnt lgkmcnt(5)
  v_cvt_pk_bf16_f32 v28, v96, v100
  v_cvt_pk_bf16_f32 v29, v104, v108
  v_mfma_f32_16x16x32_bf16 v[128:131], a[52:55], a[16:19], v[128:131]
  ds_read_b128 a[16:19], v8 offset:0
  ds_read_b128 a[32:35], v13 offset:28672
  s_mov_b32 s6, 1179648
  v_mfma_f32_16x16x32_bf16 v[132:135], a[52:55], a[20:23], v[132:135]
  ds_read_b128 a[20:23], v8 offset:1024
  buffer_store_dwordx2 v[28:29], v4, s[36:39], s6 offen nt
  v_mfma_f32_16x16x32_bf16 v[136:139], a[52:55], a[24:27], v[136:139]
  ds_read_b128 a[24:27], v8 offset:2048
  v_cvt_pk_bf16_f32 v30, v97, v101
  v_mfma_f32_16x16x32_bf16 v[140:143], a[52:55], a[28:31], v[140:143]
  s_waitcnt lgkmcnt(5)
  ds_read_b128 a[28:31], v8 offset:3072
  v_cvt_pk_bf16_f32 v31, v105, v109
  v_mfma_f32_16x16x32_bf16 v[144:147], a[56:59], a[0:3], v[144:147]
  ds_read_b128 a[36:39], v13 offset:32768
  s_mov_b32 s6, 1188864
  v_mfma_f32_16x16x32_bf16 v[148:151], a[56:59], a[4:7], v[148:151]
  buffer_store_dwordx2 v[30:31], v4, s[36:39], s6 offen nt
  v_cvt_pk_bf16_f32 v20, v98, v102
  v_mfma_f32_16x16x32_bf16 v[152:155], a[56:59], a[8:11], v[152:155]
  v_cvt_pk_bf16_f32 v21, v106, v110
  v_mfma_f32_16x16x32_bf16 v[156:159], a[56:59], a[12:15], v[156:159]
  s_waitcnt lgkmcnt(6)
  v_mfma_f32_16x16x32_bf16 v[160:163], a[60:63], a[0:3], v[160:163]
  ds_read_b128 a[0:3], v7 offset:16384
  ds_read_b128 a[40:43], v14 offset:28672
  s_mov_b32 s6, 1198080
  v_mfma_f32_16x16x32_bf16 v[164:167], a[60:63], a[4:7], v[164:167]
  ds_read_b128 a[4:7], v7 offset:17408
  buffer_store_dwordx2 v[20:21], v4, s[36:39], s6 offen nt
  v_mfma_f32_16x16x32_bf16 v[168:171], a[60:63], a[8:11], v[168:171]
  ds_read_b128 a[8:11], v7 offset:18432
  v_cvt_pk_bf16_f32 v22, v99, v103
  v_mfma_f32_16x16x32_bf16 v[172:175], a[60:63], a[12:15], v[172:175]
  s_waitcnt lgkmcnt(8)
  ds_read_b128 a[12:15], v7 offset:19456
  v_cvt_pk_bf16_f32 v23, v107, v111
  v_mfma_f32_16x16x32_bf16 v[144:147], a[32:35], a[16:19], v[144:147]
  s_waitcnt lgkmcnt(8)
  ds_read_b128 a[44:47], v14 offset:32768
  s_mov_b32 s6, 1207296
  v_mfma_f32_16x16x32_bf16 v[148:151], a[32:35], a[20:23], v[148:151]
  s_waitcnt lgkmcnt(8)
  buffer_store_dwordx2 v[22:23], v4, s[36:39], s6 offen nt
  v_cvt_pk_bf16_f32 v24, v112, v116
  v_mfma_f32_16x16x32_bf16 v[152:155], a[32:35], a[24:27], v[152:155]
  s_waitcnt lgkmcnt(7)
  v_cvt_pk_bf16_f32 v25, v120, v124
  v_mfma_f32_16x16x32_bf16 v[156:159], a[32:35], a[28:31], v[156:159]
  s_waitcnt lgkmcnt(6)
  v_mfma_f32_16x16x32_bf16 v[160:163], a[36:39], a[16:19], v[160:163]
  ds_read_b128 a[16:19], v8 offset:16384
  ds_read_b128 a[48:51], v15 offset:28672
  s_mov_b32 s6, 1474560
  v_mfma_f32_16x16x32_bf16 v[164:167], a[36:39], a[20:23], v[164:167]
  ds_read_b128 a[20:23], v8 offset:17408
  buffer_store_dwordx2 v[24:25], v4, s[36:39], s6 offen nt
  v_mfma_f32_16x16x32_bf16 v[168:171], a[36:39], a[24:27], v[168:171]
  ds_read_b128 a[24:27], v8 offset:18432
  v_cvt_pk_bf16_f32 v26, v113, v117
  v_mfma_f32_16x16x32_bf16 v[172:175], a[36:39], a[28:31], v[172:175]
  s_waitcnt lgkmcnt(8)
  ds_read_b128 a[28:31], v8 offset:19456
  v_cvt_pk_bf16_f32 v27, v121, v125
  v_mfma_f32_16x16x32_bf16 v[144:147], a[40:43], a[0:3], v[144:147]
  s_waitcnt lgkmcnt(8)
  ds_read_b128 a[52:55], v15 offset:32768
  s_mov_b32 s6, 1483776
  v_mfma_f32_16x16x32_bf16 v[148:151], a[40:43], a[4:7], v[148:151]
  s_waitcnt lgkmcnt(8)
  buffer_store_dwordx2 v[26:27], v4, s[36:39], s6 offen nt
  v_cvt_pk_bf16_f32 v28, v114, v118
  v_mfma_f32_16x16x32_bf16 v[152:155], a[40:43], a[8:11], v[152:155]
  s_waitcnt lgkmcnt(7)
  v_cvt_pk_bf16_f32 v29, v122, v126
  v_mfma_f32_16x16x32_bf16 v[156:159], a[40:43], a[12:15], v[156:159]
  s_waitcnt lgkmcnt(6)
  v_mfma_f32_16x16x32_bf16 v[160:163], a[44:47], a[0:3], v[160:163]
  ds_read_b128 a[0:3], v7 offset:37888
  ds_read_b128 a[56:59], v16 offset:28672
  s_mov_b32 s6, 1492992
  v_mfma_f32_16x16x32_bf16 v[164:167], a[44:47], a[4:7], v[164:167]
  ds_read_b128 a[4:7], v7 offset:38912
  buffer_store_dwordx2 v[28:29], v4, s[36:39], s6 offen nt
  v_mfma_f32_16x16x32_bf16 v[168:171], a[44:47], a[8:11], v[168:171]
  ds_read_b128 a[8:11], v7 offset:39936
  v_cvt_pk_bf16_f32 v30, v115, v119
  v_mfma_f32_16x16x32_bf16 v[172:175], a[44:47], a[12:15], v[172:175]
  s_waitcnt lgkmcnt(8)
  ds_read_b128 a[12:15], v7 offset:40960
  v_cvt_pk_bf16_f32 v31, v123, v127
  v_mfma_f32_16x16x32_bf16 v[144:147], a[48:51], a[16:19], v[144:147]
  s_waitcnt lgkmcnt(8)
  ds_read_b128 a[60:63], v16 offset:32768
  s_mov_b32 s6, 1502208
  v_mfma_f32_16x16x32_bf16 v[148:151], a[48:51], a[20:23], v[148:151]
  s_waitcnt lgkmcnt(8)
  buffer_store_dwordx2 v[30:31], v4, s[36:39], s6 offen nt
  v_cvt_pk_bf16_f32 v20, v128, v132
  v_mfma_f32_16x16x32_bf16 v[152:155], a[48:51], a[24:27], v[152:155]
  s_waitcnt lgkmcnt(7)
  v_cvt_pk_bf16_f32 v21, v136, v140
  v_mfma_f32_16x16x32_bf16 v[156:159], a[48:51], a[28:31], v[156:159]
  s_waitcnt lgkmcnt(6)
  v_mfma_f32_16x16x32_bf16 v[160:163], a[52:55], a[16:19], v[160:163]
  ds_read_b128 a[16:19], v8 offset:37888
  ds_read_b128 a[32:35], v17 offset:28672
  s_mov_b32 s6, 1769472
  v_mfma_f32_16x16x32_bf16 v[164:167], a[52:55], a[20:23], v[164:167]
  ds_read_b128 a[20:23], v8 offset:38912
  buffer_store_dwordx2 v[20:21], v4, s[36:39], s6 offen nt
  v_mfma_f32_16x16x32_bf16 v[168:171], a[52:55], a[24:27], v[168:171]
  ds_read_b128 a[24:27], v8 offset:39936
  v_cvt_pk_bf16_f32 v22, v129, v133
  v_mfma_f32_16x16x32_bf16 v[172:175], a[52:55], a[28:31], v[172:175]
  s_waitcnt lgkmcnt(8)
  ds_read_b128 a[28:31], v8 offset:40960
  v_cvt_pk_bf16_f32 v23, v137, v141
  v_mfma_f32_16x16x32_bf16 v[144:147], a[56:59], a[0:3], v[144:147]
  s_waitcnt lgkmcnt(8)
  ds_read_b128 a[36:39], v17 offset:32768
  s_mov_b32 s6, 1778688
  v_mfma_f32_16x16x32_bf16 v[148:151], a[56:59], a[4:7], v[148:151]
  s_waitcnt lgkmcnt(8)
  buffer_store_dwordx2 v[22:23], v4, s[36:39], s6 offen nt
  v_cvt_pk_bf16_f32 v24, v130, v134
  v_mfma_f32_16x16x32_bf16 v[152:155], a[56:59], a[8:11], v[152:155]
  s_waitcnt lgkmcnt(7)
  v_cvt_pk_bf16_f32 v25, v138, v142
  v_mfma_f32_16x16x32_bf16 v[156:159], a[56:59], a[12:15], v[156:159]
  s_waitcnt lgkmcnt(6)
  v_mfma_f32_16x16x32_bf16 v[160:163], a[60:63], a[0:3], v[160:163]
  s_mov_b32 s6, 1787904
  v_mfma_f32_16x16x32_bf16 v[164:167], a[60:63], a[4:7], v[164:167]
  buffer_store_dwordx2 v[24:25], v4, s[36:39], s6 offen nt
  v_cvt_pk_bf16_f32 v26, v131, v135
  v_mfma_f32_16x16x32_bf16 v[168:171], a[60:63], a[8:11], v[168:171]
  v_cvt_pk_bf16_f32 v27, v139, v143
  v_mfma_f32_16x16x32_bf16 v[172:175], a[60:63], a[12:15], v[172:175]
  s_waitcnt lgkmcnt(4)
  v_mfma_f32_16x16x32_bf16 v[144:147], a[32:35], a[16:19], v[144:147]
  s_waitcnt lgkmcnt(3)
  s_mov_b32 s6, 1797120
  v_mfma_f32_16x16x32_bf16 v[148:151], a[32:35], a[20:23], v[148:151]
  s_waitcnt lgkmcnt(2)
  buffer_store_dwordx2 v[26:27], v4, s[36:39], s6 offen nt
  v_mfma_f32_16x16x32_bf16 v[152:155], a[32:35], a[24:27], v[152:155]
  s_waitcnt lgkmcnt(1)
  v_mfma_f32_16x16x32_bf16 v[156:159], a[32:35], a[28:31], v[156:159]
  s_waitcnt lgkmcnt(0)
  v_mfma_f32_16x16x32_bf16 v[160:163], a[36:39], a[16:19], v[160:163]
  v_mfma_f32_16x16x32_bf16 v[164:167], a[36:39], a[20:23], v[164:167]
  v_mfma_f32_16x16x32_bf16 v[168:171], a[36:39], a[24:27], v[168:171]
  v_mfma_f32_16x16x32_bf16 v[172:175], a[36:39], a[28:31], v[172:175]
  v_cvt_pk_bf16_f32 v28, v144, v148
  v_cvt_pk_bf16_f32 v29, v152, v156
  s_mov_b32 s6, 2064384
  buffer_store_dwordx2 v[28:29], v4, s[36:39], s6 offen nt
  v_cvt_pk_bf16_f32 v30, v145, v149
  v_cvt_pk_bf16_f32 v31, v153, v157
  s_mov_b32 s6, 2073600
  buffer_store_dwordx2 v[30:31], v4, s[36:39], s6 offen nt
  v_cvt_pk_bf16_f32 v20, v146, v150
  v_cvt_pk_bf16_f32 v21, v154, v158
  s_mov_b32 s6, 2082816
  buffer_store_dwordx2 v[20:21], v4, s[36:39], s6 offen nt
  v_cvt_pk_bf16_f32 v22, v147, v151
  v_cvt_pk_bf16_f32 v23, v155, v159
  s_mov_b32 s6, 2092032
  buffer_store_dwordx2 v[22:23], v4, s[36:39], s6 offen nt
  v_cvt_pk_bf16_f32 v24, v160, v164
  v_cvt_pk_bf16_f32 v25, v168, v172
  s_mov_b32 s6, 2359296
  buffer_store_dwordx2 v[24:25], v4, s[36:39], s6 offen nt
  v_cvt_pk_bf16_f32 v26, v161, v165
  v_cvt_pk_bf16_f32 v27, v169, v173
  s_mov_b32 s6, 2368512
  buffer_store_dwordx2 v[26:27], v4, s[36:39], s6 offen nt
  v_cvt_pk_bf16_f32 v28, v162, v166
  v_cvt_pk_bf16_f32 v29, v170, v174
  s_mov_b32 s6, 2377728
  buffer_store_dwordx2 v[28:29], v4, s[36:39], s6 offen nt
  v_cvt_pk_bf16_f32 v30, v163, v167
  v_cvt_pk_bf16_f32 v31, v171, v175
  s_mov_b32 s6, 2386944
  buffer_store_dwordx2 v[30:31], v4, s[36:39], s6 offen nt
  s_endpgm
L_endc1b:
L_end:
  s_endpgm
.section .rodata,"a"
.p2align 6
.amdhsa_kernel standalone__w4a16_gemm_dequant__prompt_kernel
  .amdhsa_next_free_vgpr 256
  .amdhsa_next_free_sgpr 102
  .amdhsa_accum_offset 192
  .amdhsa_group_segment_fixed_size 0
  .amdhsa_kernarg_size 56
  .amdhsa_user_sgpr_count 2
  .amdhsa_user_sgpr_kernarg_segment_ptr 1
  .amdhsa_system_sgpr_workgroup_id_x 1
  .amdhsa_float_denorm_mode_32 3
.end_amdhsa_kernel
```
